```python
import torch

def _softmax(x, axis=-1):
    return torch.softmax(x, dim=axis)
def _gelu(x):
    return torch.nn.functional.gelu(x, approximate="tanh")
def _silu(x):
    return torch.nn.functional.silu(x)
def _sigmoid(x):
    return torch.sigmoid(x)
def _layernorm(x, axis=-1, eps=1e-5):
    m = x.mean(dim=axis, keepdim=True)
    v = x.var(dim=axis, keepdim=True, unbiased=False)
    return (x - m) / torch.sqrt(v + eps)
def _scatter_add(tgt, idx, src, axis=0):
    return tgt.clone().index_add_(axis, idx, src)
def _segment_sum(src, seg, n):
    out = torch.zeros((n,) + src.shape[1:], dtype=src.dtype)
    return out.index_add_(0, seg, src)
def _pad(x, pw):
    flat = tuple(v for pair in reversed(pw) for v in pair)
    return torch.nn.functional.pad(x, flat)

kernel_name = 'standalone__mixer_s_mlp__prompt'

def setup_inputs():

    _w = (lambda a: (lambda t: t.to(torch.bfloat16) if t.is_floating_point() else t)(torch.as_tensor(a)))
    B, S, D, F = 1, 2048, 512, 1792
    return {
        "x":  _w((lambda *s: torch.randn(*s, dtype=torch.bfloat16) * 0.4)(B, S, D)),
        "w1": _w((lambda *s: torch.randn(*s, dtype=torch.bfloat16) * 3.2)(D, D) * (D ** -0.5)),
        "w2": _w((lambda *s: torch.randn(*s, dtype=torch.bfloat16) * 3.2)(D, D) * (D ** -0.5)),
        "w3": _w((lambda *s: torch.randn(*s, dtype=torch.bfloat16) * 3.2)(D, F) * (D ** -0.5)),
        "w4": _w((lambda *s: torch.randn(*s, dtype=torch.bfloat16) * 0.8)(F, D) * (F ** -0.5)),
    }

def reference(x, w1, w2, w3, w4):
    B, S, D = x.shape
    h = _gelu(_layernorm(x, axis=-1) @ w1)
    c = D // 4
    g0 = _pad(h[:, :, 0*c:1*c], ((0, 0), (1, 0), (0, 0)))[:, :S, :]
    g1 = _pad(h[:, :, 1*c:2*c], ((0, 0), (0, 1), (0, 0)))[:, 1:, :]
    g2 = _pad(h[:, :, 2*c:3*c], ((0, 0), (2, 0), (0, 0)))[:, :S, :]
    g3 = _pad(h[:, :, 3*c:   ], ((0, 0), (0, 2), (0, 0)))[:, 2:, :]
    hs = torch.concatenate([g0, g1, g2, g3], axis=-1) @ w2
    x1 = x + hs
    h2 = _gelu(_layernorm(x1, axis=-1) @ w3) @ w4
    return x1 + h2
```

```asm
; @launch grid=(256,1,1) block=(256,1,1) lds=163840
.amdgcn_target "amdgcn-amd-amdhsa--gfx950"
.text
.globl standalone__mixer_s_mlp__prompt_kernel
.p2align 8
.type standalone__mixer_s_mlp__prompt_kernel,@function
standalone__mixer_s_mlp__prompt_kernel:
    s_cmp_ge_u32 s2, 256
    s_cbranch_scc1 KEND
    s_load_dwordx16 s[16:31], s[0:1], 0
    v_lshrrev_b32 v1, 6, v0
    v_and_b32 v0, 63, v0
    v_readfirstlane_b32 s60, v1
    s_and_b32 s65, s2, 7
    s_lshr_b32 s82, s2, 3
    s_and_b32 s62, s82, 7
    s_lshr_b32 s66, s82, 3
    s_lshl_b32 s65, s65, 2
    s_add_u32 s61, s65, s66
    s_lshl_b32 s66, s66, 1
    s_add_u32 s64, s66, s62
    s_and_b32 s64, s64, 7
    s_lshr_b32 s65, s62, 2
    s_add_u32 s65, s65, 1
    s_sub_u32 s68, 0, s65
    s_bitcmp1_b32 s62, 1
    s_cselect_b32 s68, s65, s68
    s_lshl_b32 s67, s61, 6
    s_lshl_b32 s65, s60, 4
    s_add_u32 s67, s67, s65
    v_and_b32 v2, 15, v0
    v_lshrrev_b32 v3, 4, v0
    s_lshl_b32 s66, s62, 7
    v_lshrrev_b32 v4, 3, v0
    v_and_b32 v5, 7, v0
    s_add_u32 s68, s68, s67
    s_movk_i32 s69, 2047
    v_xor_b32 v6, v5, v3
    v_lshlrev_b32 v6, 4, v6
    v_add_u32 v7, s68, v4
    v_add_u32 v8, 8, v7
    v_med3_i32 v7, v7, 0, s69
    v_med3_i32 v8, v8, 0, s69
    v_lshl_add_u32 v32, v7, 10, v6
    v_xor_b32 v6, 64, v6
    v_lshl_add_u32 v114, v8, 10, v6
    v_subrev_u32 v114, 0x400, v114
    v_add_u32 v8, s65, v4
    v_lshlrev_b32 v8, 10, v8
    v_add_u32 v8, s66, v8
    v_bfe_u32 v6, v0, 4, 1
    v_lshlrev_b32 v6, 1, v6
    v_xor_b32 v6, v5, v6
    v_lshl_add_u32 v33, v6, 4, v8
    v_xor_b32 v6, 4, v6
    v_lshl_add_u32 v34, v6, 4, v8
    v_add_u32 v34, 7168, v34
    s_lshl_b32 s69, s60, 11
    s_mul_i32 s75, s60, 6144
    s_add_u32 s75, s75, 131072
    s_lshl_b32 s91, s64, 7
    s_lshl_b32 s93, s64, 16
    s_waitcnt lgkmcnt(0)
    s_mov_b32 s32, s16
    s_mov_b32 s33, s17
    s_mov_b32 s34, 0x200000
    s_mov_b32 s35, 0x00020000
    s_mov_b32 s36, s18
    s_mov_b32 s37, s19
    s_mov_b32 s38, 0x80000
    s_mov_b32 s39, 0x00020000
    s_mov_b32 s40, s20
    s_mov_b32 s41, s21
    s_mov_b32 s42, 0x80000
    s_mov_b32 s43, 0x00020000
    s_add_u32 m0, s69, 0
    s_lshl_b32 s92, s91, 9
    buffer_load_dwordx4 v33, s[36:39], s92 offen lds
    buffer_load_dwordx4 v34, s[36:39], s92 offen offset:1024 lds
    s_add_u32 m0, s75, 0
    s_nop 0
    buffer_load_dwordx4 v32, s[32:35], s91 offen lds
    buffer_load_dwordx4 v114, s[32:35], s91 offen offset:1024 lds
    s_add_u32 s91, s91, 128
    s_and_b32 s91, s91, 1023
    s_mov_b32 s56, s30
    s_mov_b32 s57, s31
    s_mov_b32 s58, 0x2000000
    s_mov_b32 s59, 0x00020000
    v_lshlrev_b32 v10, 4, v0
    v_mov_b32 v116, -1
    v_mov_b32 v117, -1
    v_mov_b32 v118, -1
    v_mov_b32 v119, -1
    s_lshl_b32 s74, s60, 14
    s_lshl_b32 s71, s61, 16
    s_add_u32 s71, s71, s74
    s_lshl_b32 s11, s62, 11
    s_add_u32 s11, s11, s71
    s_add_u32 s12, s11, 0x200000
    buffer_store_dwordx4 v[116:119], v10, s[56:59], s11 offen offset:0 sc1
    buffer_store_dwordx4 v[116:119], v10, s[56:59], s11 offen offset:1024 sc1
    s_add_u32 m0, s69, 8192
    s_lshl_b32 s92, s91, 9
    buffer_load_dwordx4 v33, s[36:39], s92 offen lds
    buffer_load_dwordx4 v34, s[36:39], s92 offen offset:1024 lds
    s_add_u32 m0, s75, 2048
    s_nop 0
    buffer_load_dwordx4 v32, s[32:35], s91 offen lds
    buffer_load_dwordx4 v114, s[32:35], s91 offen offset:1024 lds
    s_add_u32 s91, s91, 128
    s_and_b32 s91, s91, 1023
    s_add_u32 m0, s69, 16384
    s_lshl_b32 s92, s91, 9
    buffer_load_dwordx4 v33, s[36:39], s92 offen lds
    buffer_load_dwordx4 v34, s[36:39], s92 offen offset:1024 lds
    s_add_u32 m0, s75, 4096
    s_nop 0
    buffer_load_dwordx4 v32, s[32:35], s91 offen lds
    buffer_load_dwordx4 v114, s[32:35], s91 offen offset:1024 lds
    s_add_u32 s91, s91, 128
    s_and_b32 s91, s91, 1023
    s_mov_b32 s44, s22
    s_mov_b32 s45, s23
    s_mov_b32 s46, 0x1c0000
    s_mov_b32 s47, 0x00020000
    s_mov_b32 s48, s24
    s_mov_b32 s49, s25
    s_mov_b32 s50, 0x1c0000
    s_mov_b32 s51, 0x00020000
    s_mov_b32 s52, s26
    s_mov_b32 s53, s27
    s_mov_b32 s54, 0x200000
    s_mov_b32 s55, 0x00020000
    s_mov_b32 s78, 0x10000
    s_lshl_b32 s73, s61, 12
    s_add_u32 s73, s73, 0xc00000
    s_add_u32 s65, s73, 2048
    s_load_dword s63, s[30:31], s65
    s_lshl_b32 s65, s82, 2
    s_add_u32 s65, s65, s60
    s_lshl_b32 s65, s65, 2
    s_getpc_b64 s[84:85]
HOP_PC:
    s_add_u32 s84, s84, s65
    s_addc_u32 s85, s85, 0
    s_add_u32 s84, s84, HOP_TAB-HOP_PC
    s_addc_u32 s85, s85, 0
    s_mov_b64 exec, 0
    s_setpc_b64 s[84:85]
HOP_RET:
    s_mov_b64 exec, -1
    s_add_u32 m0, s69, 24576
HOP0:
    s_cbranch_execz HOP_RET
    s_lshl_b32 s92, s91, 9
    buffer_load_dwordx4 v33, s[36:39], s92 offen lds
    buffer_load_dwordx4 v34, s[36:39], s92 offen offset:1024 lds
    s_add_u32 m0, s69, 155648
    s_nop 0
    buffer_load_dwordx4 v32, s[32:35], s91 offen lds
    buffer_load_dwordx4 v114, s[32:35], s91 offen offset:1024 lds
    s_add_u32 s91, s91, 128
    s_and_b32 s91, s91, 1023
    v_lshlrev_b32 v6, 1, v3
    v_xor_b32 v6, v5, v6
    v_lshl_add_u32 v35, v6, 4, v8
    v_add_u32 v22, 7168, v35
    s_lshl_b32 s65, s61, 16
    v_add_u32 v8, s65, v8
    v_xor_b32 v6, v5, v3
    v_lshl_add_u32 v23, v6, 4, v8
    v_xor_b32 v6, 4, v6
    v_lshl_add_u32 v113, v6, 4, v8
    v_add_u32 v113, 7168, v113
    v_lshrrev_b32 v6, 1, v2
    v_xor_b32 v6, v6, v3
    v_lshlrev_b32 v6, 4, v6
    v_lshl_add_u32 v6, v2, 7, v6
    v_add_u32 v40, s75, v6
    v_xor_b32 v41, 64, v40
    s_add_u32 s65, s69, 155648
    v_add_u32 v42, s65, v6
    v_xor_b32 v43, 64, v42
    v_add_u32 v6, s68, v2
    v_mov_b32 v7, 0x7ff
    v_cmp_gt_u32 s[14:15], v6, v7
    v_lshrrev_b32 v4, 2, v2
    v_and_b32 v5, 3, v2
    v_lshl_add_u32 v6, v3, 3, v4
    v_lshlrev_b32 v6, 7, v6
    v_lshl_add_u32 v6, v5, 3, v6
    v_and_b32 v7, 1, v3
    v_lshrrev_b32 v8, 1, v4
    v_lshl_or_b32 v8, v7, 1, v8
    v_xor_b32 v8, s60, v8
    v_xor_b32 v9, 0, v8
HOP1:
    s_cbranch_execz HOP_RET
    v_lshl_add_u32 v36, v9, 5, v6
    v_xor_b32 v9, 1, v8
    v_lshl_add_u32 v37, v9, 5, v6
    v_xor_b32 v9, 2, v8
    v_lshl_add_u32 v38, v9, 5, v6
    v_xor_b32 v9, 3, v8
    v_lshl_add_u32 v39, v9, 5, v6
    v_mov_b32 v24, 0x3f803f80
    v_mov_b32 v25, 0x3f803f80
    v_mov_b32 v26, 0x3f803f80
    v_mov_b32 v27, 0x3f803f80
    s_waitcnt lgkmcnt(0)
    s_mul_i32 s63, s63, 0x9e3779b1
    s_add_u32 s63, s63, 0x7f4a7c15
    s_getreg_b32 s5, hwreg(HW_REG_XCC_ID, 0, 4)
    s_andn2_b32 s65, s63, 15
    s_or_b32 s5, s5, s65
    v_mov_b32 v21, s5
    s_mul_i32 s72, s61, 229376
    s_add_u32 s72, s72, 0x400000
    v_and_b32 v8, 7, v0
    s_lshl_b32 s65, s60, 7
    v_lshlrev_b32 v8, 2, v8
    v_add_u32 v20, s65, v8
    s_lshl_b32 s66, s62, 2
    s_add_u32 s65, s65, s66
    s_add_u32 s70, s65, s73
    s_and_b32 s66, s62, 1
    s_lshl_b32 s67, s66, 2
    s_add_u32 s67, s67, s60
    s_cmp_eq_u32 s60, 3
    s_cselect_b32 s67, 3, s67
    s_cselect_b32 s66, s66, 0
    s_lshr_b32 s65, s62, 1
    s_mul_i32 s65, s65, 7
    s_add_u32 s67, s67, s65
    s_lshl_b32 s76, s67, 1
    s_add_u32 s76, s76, s66
    s_lshl_b32 s76, s76, 12
    s_add_u32 s76, s76, s72
    s_add_u32 s77, s76, 4096
    s_cmp_eq_u32 s60, 3
    s_cselect_b32 s77, 0x7f000000, s77
    v_lshrrev_b32 v6, 3, v0
    v_and_b32 v7, 7, v0
    v_bfe_u32 v8, v0, 4, 1
HOP2:
    s_cbranch_execz HOP_RET
    v_lshlrev_b32 v8, 2, v8
    v_xor_b32 v8, v7, v8
    v_lshlrev_b32 v9, 10, v6
    v_lshl_add_u32 v13, v8, 4, v9
    s_mul_i32 s65, s60, 458752
    s_lshl_b32 s68, s62, 7
    s_add_u32 s65, s65, s68
    v_add_u32 v13, s65, v13
    v_add_u32 v14, 7168, v13
    s_and_b32 s65, s60, 1
    s_xor_b32 s66, s66, s65
    s_lshl_b32 s66, s66, 2
    v_xor_b32 v8, s66, v8
    s_movk_i32 s68, 3584
    v_mul_lo_u32 v6, v6, s68
    s_lshl_b32 s67, s67, 7
    v_lshl_add_u32 v6, v8, 4, v6
    v_add_u32 v11, s67, v6
    v_lshrrev_b32 v8, 2, v8
    s_and_b32 s66, s62, 1
    s_xor_b32 s66, s66, 1
    s_cmp_eq_u32 s60, 3
    s_cselect_b32 s66, s66, 2
    v_cmp_eq_u32 vcc, s66, v8
    v_bfrev_b32 v9, 2
    v_cndmask_b32 v11, v11, v9, vcc
    v_add_u32 v12, 56320, v11
    s_mul_i32 s79, s64, 229376
    v_mul_lo_u32 v6, v0, s68
    v_add_u32 v250, s67, v6
    s_add_u32 s80, s64, 1
    s_and_b32 s80, s80, 7
    s_mul_i32 s80, s80, 229376
    s_and_b32 s66, s61, 3
    s_lshl_b32 s67, s60, 2
    s_add_u32 s66, s66, s67
    s_mul_i32 s66, s66, 114688
    s_lshl_b32 s67, s62, 7
    s_add_u32 s66, s66, s67
    v_lshlrev_b32 v6, 10, v0
    v_add_u32 v251, s66, v6
    s_mov_b32 s6, 0xca876420
    s_mov_b32 s7, 0xca876420
    s_lshl_b32 s66, s64, 2
    s_lshr_b64 s[6:7], s[6:7], s66
    s_mov_b32 s8, 0x31db9531
    s_mov_b32 s9, 0xdb95
HOP3:
    s_cbranch_execz HOP_RET
    s_mul_i32 s66, s64, 3
    s_and_b32 s66, s66, 0x1c
    s_lshr_b64 s[8:9], s[8:9], s66
    s_mul_i32 s10, s60, 57344
    s_add_u32 s10, s10, s72
    v_lshrrev_b32 v4, 2, v2
    v_and_b32 v5, 3, v2
    v_lshrrev_b32 v6, 1, v3
    v_and_b32 v7, 1, v3
    v_lshl_add_u32 v8, v6, 2, v4
    v_lshlrev_b32 v9, 5, v7
    v_lshl_add_u32 v9, v5, 3, v9
    v_lshl_add_u32 v9, v8, 7, v9
    v_add_u32 v9, s75, v9
    v_bfe_u32 v8, v4, 1, 1
    v_xor_b32 v8, s65, v8
    v_lshl_add_u32 v15, v8, 6, v9
    v_xor_b32 v8, 1, v8
    v_lshl_add_u32 v16, v8, 6, v9
    v_lshl_add_u32 v8, v6, 4, v2
    v_lshlrev_b32 v8, 4, v8
    v_lshl_add_u32 v17, v7, 14, v8
    v_xor_b32 v8, v3, v2
    v_and_b32 v8, 1, v8
    v_cmp_eq_u32 vcc, 0, v8
    v_lshlrev_b32 v9, 4, v3
    v_add_u32 v112, 155648, v9
    v_cndmask_b32 v28, 0, v24, vcc
    v_add_u32 v112, s69, v112
    v_mov_b32 v29, v28
    v_mov_b32 v30, v28
    v_mov_b32 v31, v28
    s_waitcnt vmcnt(14)
    s_barrier
    ds_read_b128 v[120:123], v40 offset:0
    ds_read_b128 v[124:127], v41 offset:0
    ds_read_b64_tr_b16 v[80:81], v36 offset:0
    ds_read_b64_tr_b16 v[82:83], v36 offset:512
    ds_read_b64_tr_b16 v[84:85], v37 offset:0
    ds_read_b64_tr_b16 v[86:87], v37 offset:512
    ds_read_b64_tr_b16 v[88:89], v38 offset:0
    ds_read_b64_tr_b16 v[90:91], v38 offset:512
    ds_read_b64_tr_b16 v[92:93], v39 offset:0
HOP4:
    s_cbranch_execz HOP_RET
    ds_read_b64_tr_b16 v[94:95], v39 offset:512
    s_waitcnt lgkmcnt(8)
    v_mfma_f32_16x16x32_bf16 v[60:63], v[24:27], v[120:123], 0
    buffer_store_dwordx4 v[116:119], v10, s[56:59], s12 offen offset:0 sc1
    v_mfma_f32_16x16x32_bf16 v[64:67], v[120:123], v[120:123], 0
    s_waitcnt lgkmcnt(4)
    v_mfma_f32_16x16x32_bf16 v[44:47], v[80:83], v[120:123], 0
    ds_read_b64_tr_b16 v[96:97], v36 offset:4096
    ds_read_b64_tr_b16 v[98:99], v36 offset:4608
    v_mfma_f32_16x16x32_bf16 v[48:51], v[84:87], v[120:123], 0
    ds_read_b64_tr_b16 v[100:101], v37 offset:4096
    ds_read_b64_tr_b16 v[102:103], v37 offset:4608
    buffer_store_dwordx4 v[116:119], v10, s[56:59], s12 offen offset:1024 sc1
    s_waitcnt lgkmcnt(4)
    v_mfma_f32_16x16x32_bf16 v[52:55], v[88:91], v[120:123], 0
    ds_read_b64_tr_b16 v[104:105], v38 offset:4096
    ds_read_b64_tr_b16 v[106:107], v38 offset:4608
    v_mfma_f32_16x16x32_bf16 v[56:59], v[92:95], v[120:123], 0
    ds_read_b64_tr_b16 v[108:109], v39 offset:4096
    ds_read_b64_tr_b16 v[110:111], v39 offset:4608
    v_mfma_f32_16x16x32_bf16 v[68:71], v[80:83], v[24:27], 0
    v_mfma_f32_16x16x32_bf16 v[60:63], v[24:27], v[124:127], v[60:63]
    s_add_u32 m0, s69, 32768
    s_lshl_b32 s92, s91, 9
    buffer_load_dwordx4 v33, s[36:39], s92 offen lds
    v_mfma_f32_16x16x32_bf16 v[64:67], v[124:127], v[124:127], v[64:67]
    s_waitcnt vmcnt(11)
    s_barrier
    ds_read_b128 v[128:131], v40 offset:2048
    ds_read_b128 v[132:135], v41 offset:2048
    s_mov_b64 exec, 1
    buffer_store_dword v21, off, s[56:59], s70 sc1
    s_mov_b64 exec, -1
    v_lshlrev_b32 v115, 5, v0
    buffer_load_dword v115, v115, s[56:59], s11 offen sc1
HOP5:
    s_cbranch_execz HOP_RET
    s_waitcnt lgkmcnt(6)
    v_mfma_f32_16x16x32_bf16 v[44:47], v[96:99], v[124:127], v[44:47]
    ds_read_b64_tr_b16 v[80:81], v36 offset:8192
    ds_read_b64_tr_b16 v[82:83], v36 offset:8704
    v_mfma_f32_16x16x32_bf16 v[48:51], v[100:103], v[124:127], v[48:51]
    ds_read_b64_tr_b16 v[84:85], v37 offset:8192
    ds_read_b64_tr_b16 v[86:87], v37 offset:8704
    buffer_load_dwordx4 v34, s[36:39], s92 offen offset:1024 lds
    s_add_u32 m0, s75, 0
    s_waitcnt lgkmcnt(6)
    v_mfma_f32_16x16x32_bf16 v[52:55], v[104:107], v[124:127], v[52:55]
    ds_read_b64_tr_b16 v[88:89], v38 offset:8192
    ds_read_b64_tr_b16 v[90:91], v38 offset:8704
    v_mfma_f32_16x16x32_bf16 v[56:59], v[108:111], v[124:127], v[56:59]
    ds_read_b64_tr_b16 v[92:93], v39 offset:8192
    ds_read_b64_tr_b16 v[94:95], v39 offset:8704
    v_mfma_f32_16x16x32_bf16 v[68:71], v[96:99], v[24:27], v[68:71]
    s_waitcnt lgkmcnt(8)
    v_mfma_f32_16x16x32_bf16 v[60:63], v[24:27], v[128:131], v[60:63]
    buffer_load_dwordx4 v32, s[32:35], s91 offen lds
    v_mfma_f32_16x16x32_bf16 v[64:67], v[128:131], v[128:131], v[64:67]
    s_waitcnt lgkmcnt(4)
    v_mfma_f32_16x16x32_bf16 v[44:47], v[80:83], v[128:131], v[44:47]
    ds_read_b64_tr_b16 v[96:97], v36 offset:12288
    ds_read_b64_tr_b16 v[98:99], v36 offset:12800
    v_mfma_f32_16x16x32_bf16 v[48:51], v[84:87], v[128:131], v[48:51]
    ds_read_b64_tr_b16 v[100:101], v37 offset:12288
    ds_read_b64_tr_b16 v[102:103], v37 offset:12800
    buffer_load_dwordx4 v114, s[32:35], s91 offen offset:1024 lds
    s_add_u32 s91, s91, 128
    s_and_b32 s91, s91, 1023
    s_waitcnt lgkmcnt(4)
    v_mfma_f32_16x16x32_bf16 v[52:55], v[88:91], v[128:131], v[52:55]
    ds_read_b64_tr_b16 v[104:105], v38 offset:12288
HOP6:
    s_cbranch_execz HOP_RET
    ds_read_b64_tr_b16 v[106:107], v38 offset:12800
    v_mfma_f32_16x16x32_bf16 v[56:59], v[92:95], v[128:131], v[56:59]
    ds_read_b64_tr_b16 v[108:109], v39 offset:12288
    ds_read_b64_tr_b16 v[110:111], v39 offset:12800
    v_mfma_f32_16x16x32_bf16 v[68:71], v[80:83], v[24:27], v[68:71]
    v_mfma_f32_16x16x32_bf16 v[60:63], v[24:27], v[132:135], v[60:63]
    s_add_u32 m0, s69, 40960
    s_lshl_b32 s92, s91, 9
    buffer_load_dwordx4 v33, s[36:39], s92 offen lds
    v_mfma_f32_16x16x32_bf16 v[64:67], v[132:135], v[132:135], v[64:67]
    s_waitcnt vmcnt(13)
    s_barrier
    ds_read_b128 v[136:139], v40 offset:4096
    ds_read_b128 v[140:143], v41 offset:4096
    s_waitcnt lgkmcnt(6)
    v_mfma_f32_16x16x32_bf16 v[44:47], v[96:99], v[132:135], v[44:47]
    ds_read_b64_tr_b16 v[80:81], v36 offset:16384
    ds_read_b64_tr_b16 v[82:83], v36 offset:16896
    v_mfma_f32_16x16x32_bf16 v[48:51], v[100:103], v[132:135], v[48:51]
    ds_read_b64_tr_b16 v[84:85], v37 offset:16384
    ds_read_b64_tr_b16 v[86:87], v37 offset:16896
    buffer_load_dwordx4 v34, s[36:39], s92 offen offset:1024 lds
    s_add_u32 m0, s75, 2048
    s_waitcnt lgkmcnt(6)
    v_mfma_f32_16x16x32_bf16 v[52:55], v[104:107], v[132:135], v[52:55]
    ds_read_b64_tr_b16 v[88:89], v38 offset:16384
    ds_read_b64_tr_b16 v[90:91], v38 offset:16896
    v_mfma_f32_16x16x32_bf16 v[56:59], v[108:111], v[132:135], v[56:59]
    ds_read_b64_tr_b16 v[92:93], v39 offset:16384
    ds_read_b64_tr_b16 v[94:95], v39 offset:16896
    v_mfma_f32_16x16x32_bf16 v[68:71], v[96:99], v[24:27], v[68:71]
    s_waitcnt lgkmcnt(8)
    v_mfma_f32_16x16x32_bf16 v[60:63], v[24:27], v[136:139], v[60:63]
    buffer_load_dwordx4 v32, s[32:35], s91 offen lds
HOP7:
    s_cbranch_execz HOP_RET
    v_mfma_f32_16x16x32_bf16 v[64:67], v[136:139], v[136:139], v[64:67]
    s_waitcnt lgkmcnt(4)
    v_mfma_f32_16x16x32_bf16 v[44:47], v[80:83], v[136:139], v[44:47]
    ds_read_b64_tr_b16 v[96:97], v36 offset:20480
    ds_read_b64_tr_b16 v[98:99], v36 offset:20992
    v_mfma_f32_16x16x32_bf16 v[48:51], v[84:87], v[136:139], v[48:51]
    ds_read_b64_tr_b16 v[100:101], v37 offset:20480
    ds_read_b64_tr_b16 v[102:103], v37 offset:20992
    buffer_load_dwordx4 v114, s[32:35], s91 offen offset:1024 lds
    s_add_u32 s91, s91, 128
    s_and_b32 s91, s91, 1023
    s_waitcnt lgkmcnt(4)
    v_mfma_f32_16x16x32_bf16 v[52:55], v[88:91], v[136:139], v[52:55]
    ds_read_b64_tr_b16 v[104:105], v38 offset:20480
    ds_read_b64_tr_b16 v[106:107], v38 offset:20992
    v_mfma_f32_16x16x32_bf16 v[56:59], v[92:95], v[136:139], v[56:59]
    ds_read_b64_tr_b16 v[108:109], v39 offset:20480
    ds_read_b64_tr_b16 v[110:111], v39 offset:20992
    v_mfma_f32_16x16x32_bf16 v[68:71], v[80:83], v[24:27], v[68:71]
    v_mfma_f32_16x16x32_bf16 v[60:63], v[24:27], v[140:143], v[60:63]
    s_add_u32 m0, s69, 49152
    s_lshl_b32 s92, s91, 9
    buffer_load_dwordx4 v33, s[36:39], s92 offen lds
    v_mfma_f32_16x16x32_bf16 v[64:67], v[140:143], v[140:143], v[64:67]
    s_waitcnt vmcnt(13)
    s_barrier
    ds_read_b128 v[144:147], v42 offset:0
    ds_read_b128 v[148:151], v43 offset:0
    s_waitcnt lgkmcnt(6)
    v_mfma_f32_16x16x32_bf16 v[44:47], v[96:99], v[140:143], v[44:47]
    ds_read_b64_tr_b16 v[80:81], v36 offset:24576
    ds_read_b64_tr_b16 v[82:83], v36 offset:25088
    v_mfma_f32_16x16x32_bf16 v[48:51], v[100:103], v[140:143], v[48:51]
    ds_read_b64_tr_b16 v[84:85], v37 offset:24576
HOP8:
    s_cbranch_execz HOP_RET
    ds_read_b64_tr_b16 v[86:87], v37 offset:25088
    buffer_load_dwordx4 v34, s[36:39], s92 offen offset:1024 lds
    s_add_u32 m0, s75, 4096
    s_waitcnt lgkmcnt(6)
    v_mfma_f32_16x16x32_bf16 v[52:55], v[104:107], v[140:143], v[52:55]
    ds_read_b64_tr_b16 v[88:89], v38 offset:24576
    ds_read_b64_tr_b16 v[90:91], v38 offset:25088
    v_mfma_f32_16x16x32_bf16 v[56:59], v[108:111], v[140:143], v[56:59]
    ds_read_b64_tr_b16 v[92:93], v39 offset:24576
    ds_read_b64_tr_b16 v[94:95], v39 offset:25088
    v_mfma_f32_16x16x32_bf16 v[68:71], v[96:99], v[24:27], v[68:71]
    s_waitcnt lgkmcnt(8)
    v_mfma_f32_16x16x32_bf16 v[60:63], v[24:27], v[144:147], v[60:63]
    buffer_load_dwordx4 v32, s[32:35], s91 offen lds
    v_mfma_f32_16x16x32_bf16 v[64:67], v[144:147], v[144:147], v[64:67]
    s_waitcnt lgkmcnt(4)
    v_mfma_f32_16x16x32_bf16 v[44:47], v[80:83], v[144:147], v[44:47]
    ds_read_b64_tr_b16 v[96:97], v36 offset:28672
    ds_read_b64_tr_b16 v[98:99], v36 offset:29184
    v_mfma_f32_16x16x32_bf16 v[48:51], v[84:87], v[144:147], v[48:51]
    ds_read_b64_tr_b16 v[100:101], v37 offset:28672
    ds_read_b64_tr_b16 v[102:103], v37 offset:29184
    buffer_load_dwordx4 v114, s[32:35], s91 offen offset:1024 lds
    s_add_u32 s91, s91, 128
    s_and_b32 s91, s91, 1023
    s_waitcnt lgkmcnt(4)
    v_mfma_f32_16x16x32_bf16 v[52:55], v[88:91], v[144:147], v[52:55]
    ds_read_b64_tr_b16 v[104:105], v38 offset:28672
    ds_read_b64_tr_b16 v[106:107], v38 offset:29184
    v_mfma_f32_16x16x32_bf16 v[56:59], v[92:95], v[144:147], v[56:59]
    ds_read_b64_tr_b16 v[108:109], v39 offset:28672
    ds_read_b64_tr_b16 v[110:111], v39 offset:29184
    v_mfma_f32_16x16x32_bf16 v[68:71], v[80:83], v[24:27], v[68:71]
HOP9:
    s_cbranch_execz HOP_RET
    v_mfma_f32_16x16x32_bf16 v[60:63], v[24:27], v[148:151], v[60:63]
    s_add_u32 m0, s69, 57344
    s_lshl_b32 s92, s91, 9
    buffer_load_dwordx4 v33, s[36:39], s92 offen lds
    v_mfma_f32_16x16x32_bf16 v[64:67], v[148:151], v[148:151], v[64:67]
    s_waitcnt vmcnt(9)
    s_barrier
    ds_read_b128 v[152:155], v40 offset:0
    ds_read_b128 v[156:159], v41 offset:0
    v_lshlrev_b32 v116, 5, v0
    buffer_load_dword v117, v116, s[56:59], s12 offen sc1
    s_waitcnt lgkmcnt(6)
    v_mfma_f32_16x16x32_bf16 v[44:47], v[96:99], v[148:151], v[44:47]
    ds_read_b64_tr_b16 v[80:81], v36 offset:32768
    ds_read_b64_tr_b16 v[82:83], v36 offset:33280
    v_mfma_f32_16x16x32_bf16 v[48:51], v[100:103], v[148:151], v[48:51]
    ds_read_b64_tr_b16 v[84:85], v37 offset:32768
    ds_read_b64_tr_b16 v[86:87], v37 offset:33280
    buffer_load_dwordx4 v34, s[36:39], s92 offen offset:1024 lds
    s_add_u32 m0, s69, 155648
    s_waitcnt lgkmcnt(6)
    v_mfma_f32_16x16x32_bf16 v[52:55], v[104:107], v[148:151], v[52:55]
    ds_read_b64_tr_b16 v[88:89], v38 offset:32768
    ds_read_b64_tr_b16 v[90:91], v38 offset:33280
    v_mfma_f32_16x16x32_bf16 v[56:59], v[108:111], v[148:151], v[56:59]
    ds_read_b64_tr_b16 v[92:93], v39 offset:32768
    ds_read_b64_tr_b16 v[94:95], v39 offset:33280
    v_mfma_f32_16x16x32_bf16 v[68:71], v[96:99], v[24:27], v[68:71]
    s_waitcnt lgkmcnt(8)
    v_mfma_f32_16x16x32_bf16 v[60:63], v[24:27], v[152:155], v[60:63]
    buffer_load_dwordx4 v32, s[32:35], s91 offen lds
    v_mfma_f32_16x16x32_bf16 v[64:67], v[152:155], v[152:155], v[64:67]
    s_waitcnt lgkmcnt(4)
    v_mfma_f32_16x16x32_bf16 v[44:47], v[80:83], v[152:155], v[44:47]
    ds_read_b64_tr_b16 v[96:97], v36 offset:36864
HOP10:
    s_cbranch_execz HOP_RET
    ds_read_b64_tr_b16 v[98:99], v36 offset:37376
    v_mfma_f32_16x16x32_bf16 v[48:51], v[84:87], v[152:155], v[48:51]
    ds_read_b64_tr_b16 v[100:101], v37 offset:36864
    ds_read_b64_tr_b16 v[102:103], v37 offset:37376
    buffer_load_dwordx4 v114, s[32:35], s91 offen offset:1024 lds
    s_waitcnt lgkmcnt(4)
    v_mfma_f32_16x16x32_bf16 v[52:55], v[88:91], v[152:155], v[52:55]
    ds_read_b64_tr_b16 v[104:105], v38 offset:36864
    ds_read_b64_tr_b16 v[106:107], v38 offset:37376
    v_mfma_f32_16x16x32_bf16 v[56:59], v[92:95], v[152:155], v[56:59]
    ds_read_b64_tr_b16 v[108:109], v39 offset:36864
    ds_read_b64_tr_b16 v[110:111], v39 offset:37376
    v_mfma_f32_16x16x32_bf16 v[68:71], v[80:83], v[24:27], v[68:71]
    v_mfma_f32_16x16x32_bf16 v[60:63], v[24:27], v[156:159], v[60:63]
    s_add_u32 m0, s69, 65536
    s_nop 0
    buffer_load_dwordx4 v35, s[40:43], s93 offen lds
    v_mfma_f32_16x16x32_bf16 v[64:67], v[156:159], v[156:159], v[64:67]
    s_waitcnt vmcnt(10)
    s_barrier
    ds_read_b128 v[160:163], v40 offset:2048
    ds_read_b128 v[164:167], v41 offset:2048
    s_waitcnt lgkmcnt(6)
    v_mfma_f32_16x16x32_bf16 v[44:47], v[96:99], v[156:159], v[44:47]
    ds_read_b64_tr_b16 v[80:81], v36 offset:40960
    ds_read_b64_tr_b16 v[82:83], v36 offset:41472
    v_mfma_f32_16x16x32_bf16 v[48:51], v[100:103], v[156:159], v[48:51]
    ds_read_b64_tr_b16 v[84:85], v37 offset:40960
    ds_read_b64_tr_b16 v[86:87], v37 offset:41472
    buffer_load_dwordx4 v22, s[40:43], s93 offen offset:1024 lds
    s_waitcnt lgkmcnt(6)
    v_mfma_f32_16x16x32_bf16 v[52:55], v[104:107], v[156:159], v[52:55]
    ds_read_b64_tr_b16 v[88:89], v38 offset:40960
    ds_read_b64_tr_b16 v[90:91], v38 offset:41472
HOP11:
    s_cbranch_execz HOP_RET
    v_mfma_f32_16x16x32_bf16 v[56:59], v[108:111], v[156:159], v[56:59]
    ds_read_b64_tr_b16 v[92:93], v39 offset:40960
    ds_read_b64_tr_b16 v[94:95], v39 offset:41472
    v_mfma_f32_16x16x32_bf16 v[68:71], v[96:99], v[24:27], v[68:71]
    s_waitcnt lgkmcnt(8)
    v_mfma_f32_16x16x32_bf16 v[60:63], v[24:27], v[160:163], v[60:63]
    s_add_u32 m0, s69, 73728
    s_add_u32 s93, s93, 0x10000
    s_and_b32 s93, s93, 0x7ffff
    buffer_load_dwordx4 v35, s[40:43], s93 offen lds
    v_mfma_f32_16x16x32_bf16 v[64:67], v[160:163], v[160:163], v[64:67]
    s_waitcnt lgkmcnt(4)
    v_mfma_f32_16x16x32_bf16 v[44:47], v[80:83], v[160:163], v[44:47]
    ds_read_b64_tr_b16 v[96:97], v36 offset:45056
    ds_read_b64_tr_b16 v[98:99], v36 offset:45568
    v_mfma_f32_16x16x32_bf16 v[48:51], v[84:87], v[160:163], v[48:51]
    ds_read_b64_tr_b16 v[100:101], v37 offset:45056
    ds_read_b64_tr_b16 v[102:103], v37 offset:45568
    buffer_load_dwordx4 v22, s[40:43], s93 offen offset:1024 lds
    s_waitcnt lgkmcnt(4)
    v_mfma_f32_16x16x32_bf16 v[52:55], v[88:91], v[160:163], v[52:55]
    ds_read_b64_tr_b16 v[104:105], v38 offset:45056
    ds_read_b64_tr_b16 v[106:107], v38 offset:45568
    v_mfma_f32_16x16x32_bf16 v[56:59], v[92:95], v[160:163], v[56:59]
    ds_read_b64_tr_b16 v[108:109], v39 offset:45056
    ds_read_b64_tr_b16 v[110:111], v39 offset:45568
    v_mfma_f32_16x16x32_bf16 v[68:71], v[80:83], v[24:27], v[68:71]
    v_mfma_f32_16x16x32_bf16 v[60:63], v[24:27], v[164:167], v[60:63]
    buffer_load_dword v1, v20, s[56:59], s73 offen offset:0 sc1
    v_mfma_f32_16x16x32_bf16 v[64:67], v[164:167], v[164:167], v[64:67]
    s_waitcnt vmcnt(10)
    s_barrier
    ds_read_b128 v[168:171], v40 offset:4096
HOP12:
    s_cbranch_execz HOP_RET
    ds_read_b128 v[172:175], v41 offset:4096
    s_waitcnt lgkmcnt(6)
    v_mfma_f32_16x16x32_bf16 v[44:47], v[96:99], v[164:167], v[44:47]
    ds_read_b64_tr_b16 v[80:81], v36 offset:49152
    ds_read_b64_tr_b16 v[82:83], v36 offset:49664
    v_mfma_f32_16x16x32_bf16 v[48:51], v[100:103], v[164:167], v[48:51]
    ds_read_b64_tr_b16 v[84:85], v37 offset:49152
    ds_read_b64_tr_b16 v[86:87], v37 offset:49664
    s_add_u32 m0, s69, 81920
    s_add_u32 s93, s93, 0x10000
    s_and_b32 s93, s93, 0x7ffff
    buffer_load_dwordx4 v35, s[40:43], s93 offen lds
    s_waitcnt lgkmcnt(6)
    v_mfma_f32_16x16x32_bf16 v[52:55], v[104:107], v[164:167], v[52:55]
    ds_read_b64_tr_b16 v[88:89], v38 offset:49152
    ds_read_b64_tr_b16 v[90:91], v38 offset:49664
    v_mfma_f32_16x16x32_bf16 v[56:59], v[108:111], v[164:167], v[56:59]
    ds_read_b64_tr_b16 v[92:93], v39 offset:49152
    ds_read_b64_tr_b16 v[94:95], v39 offset:49664
    v_mfma_f32_16x16x32_bf16 v[68:71], v[96:99], v[24:27], v[68:71]
    s_waitcnt lgkmcnt(8)
    v_mfma_f32_16x16x32_bf16 v[60:63], v[24:27], v[168:171], v[60:63]
    buffer_load_dwordx4 v22, s[40:43], s93 offen offset:1024 lds
    v_mfma_f32_16x16x32_bf16 v[64:67], v[168:171], v[168:171], v[64:67]
    s_waitcnt lgkmcnt(4)
    v_mfma_f32_16x16x32_bf16 v[44:47], v[80:83], v[168:171], v[44:47]
    ds_read_b64_tr_b16 v[96:97], v36 offset:53248
    ds_read_b64_tr_b16 v[98:99], v36 offset:53760
    v_mfma_f32_16x16x32_bf16 v[48:51], v[84:87], v[168:171], v[48:51]
    ds_read_b64_tr_b16 v[100:101], v37 offset:53248
    ds_read_b64_tr_b16 v[102:103], v37 offset:53760
    s_add_u32 m0, s69, 90112
    s_add_u32 s93, s93, 0x10000
HOP13:
    s_cbranch_execz HOP_RET
    s_and_b32 s93, s93, 0x7ffff
    buffer_load_dwordx4 v35, s[40:43], s93 offen lds
    s_waitcnt lgkmcnt(4)
    v_mfma_f32_16x16x32_bf16 v[52:55], v[88:91], v[168:171], v[52:55]
    ds_read_b64_tr_b16 v[104:105], v38 offset:53248
    ds_read_b64_tr_b16 v[106:107], v38 offset:53760
    v_mfma_f32_16x16x32_bf16 v[56:59], v[92:95], v[168:171], v[56:59]
    ds_read_b64_tr_b16 v[108:109], v39 offset:53248
    ds_read_b64_tr_b16 v[110:111], v39 offset:53760
    v_mfma_f32_16x16x32_bf16 v[68:71], v[80:83], v[24:27], v[68:71]
    v_mfma_f32_16x16x32_bf16 v[60:63], v[24:27], v[172:175], v[60:63]
    buffer_load_dwordx4 v22, s[40:43], s93 offen offset:1024 lds
    v_mfma_f32_16x16x32_bf16 v[64:67], v[172:175], v[172:175], v[64:67]
    s_waitcnt vmcnt(9)
    s_barrier
    ds_read_b128 v[176:179], v42 offset:0
    ds_read_b128 v[180:183], v43 offset:0
    s_waitcnt lgkmcnt(6)
    v_mfma_f32_16x16x32_bf16 v[44:47], v[96:99], v[172:175], v[44:47]
    ds_read_b64_tr_b16 v[80:81], v36 offset:57344
    ds_read_b64_tr_b16 v[82:83], v36 offset:57856
    v_mfma_f32_16x16x32_bf16 v[48:51], v[100:103], v[172:175], v[48:51]
    ds_read_b64_tr_b16 v[84:85], v37 offset:57344
    ds_read_b64_tr_b16 v[86:87], v37 offset:57856
    s_add_u32 m0, s69, 98304
    s_add_u32 s93, s93, 0x10000
    s_and_b32 s93, s93, 0x7ffff
    buffer_load_dwordx4 v35, s[40:43], s93 offen lds
    s_waitcnt lgkmcnt(6)
    v_mfma_f32_16x16x32_bf16 v[52:55], v[104:107], v[172:175], v[52:55]
    ds_read_b64_tr_b16 v[88:89], v38 offset:57344
    ds_read_b64_tr_b16 v[90:91], v38 offset:57856
    v_mfma_f32_16x16x32_bf16 v[56:59], v[108:111], v[172:175], v[56:59]
HOP14:
    s_cbranch_execz HOP_RET
    ds_read_b64_tr_b16 v[92:93], v39 offset:57344
    ds_read_b64_tr_b16 v[94:95], v39 offset:57856
    v_mfma_f32_16x16x32_bf16 v[68:71], v[96:99], v[24:27], v[68:71]
    s_waitcnt lgkmcnt(8)
    v_mfma_f32_16x16x32_bf16 v[60:63], v[24:27], v[176:179], v[60:63]
    buffer_load_dwordx4 v22, s[40:43], s93 offen offset:1024 lds
    v_mfma_f32_16x16x32_bf16 v[64:67], v[176:179], v[176:179], v[64:67]
    s_waitcnt lgkmcnt(4)
    v_mfma_f32_16x16x32_bf16 v[44:47], v[80:83], v[176:179], v[44:47]
    ds_read_b64_tr_b16 v[96:97], v36 offset:61440
    ds_read_b64_tr_b16 v[98:99], v36 offset:61952
    v_mfma_f32_16x16x32_bf16 v[48:51], v[84:87], v[176:179], v[48:51]
    ds_read_b64_tr_b16 v[100:101], v37 offset:61440
    ds_read_b64_tr_b16 v[102:103], v37 offset:61952
    s_add_u32 m0, s69, 106496
    s_add_u32 s93, s93, 0x10000
    s_and_b32 s93, s93, 0x7ffff
    buffer_load_dwordx4 v35, s[40:43], s93 offen lds
    s_waitcnt lgkmcnt(4)
    v_mfma_f32_16x16x32_bf16 v[52:55], v[88:91], v[176:179], v[52:55]
    ds_read_b64_tr_b16 v[104:105], v38 offset:61440
    ds_read_b64_tr_b16 v[106:107], v38 offset:61952
    v_mfma_f32_16x16x32_bf16 v[56:59], v[92:95], v[176:179], v[56:59]
    ds_read_b64_tr_b16 v[108:109], v39 offset:61440
    ds_read_b64_tr_b16 v[110:111], v39 offset:61952
    v_mfma_f32_16x16x32_bf16 v[68:71], v[80:83], v[24:27], v[68:71]
    v_mfma_f32_16x16x32_bf16 v[60:63], v[24:27], v[180:183], v[60:63]
    buffer_load_dwordx4 v22, s[40:43], s93 offen offset:1024 lds
    v_mfma_f32_16x16x32_bf16 v[64:67], v[180:183], v[180:183], v[64:67]
    s_waitcnt lgkmcnt(4)
    v_mfma_f32_16x16x32_bf16 v[44:47], v[96:99], v[180:183], v[44:47]
    v_mfma_f32_16x16x32_bf16 v[48:51], v[100:103], v[180:183], v[48:51]
    s_add_u32 m0, s69, 114688
HOP15:
    s_cbranch_execz HOP_RET
    s_add_u32 s93, s93, 0x10000
    s_and_b32 s93, s93, 0x7ffff
    buffer_load_dwordx4 v35, s[40:43], s93 offen lds
    s_waitcnt lgkmcnt(0)
    v_mfma_f32_16x16x32_bf16 v[52:55], v[104:107], v[180:183], v[52:55]
    v_mfma_f32_16x16x32_bf16 v[56:59], v[108:111], v[180:183], v[56:59]
    v_mfma_f32_16x16x32_bf16 v[68:71], v[96:99], v[24:27], v[68:71]
    v_and_b32 v4, 3, v0
    v_lshrrev_b32 v5, 2, v2
    v_lshl_add_u32 v5, v5, 4, v2
    v_lshlrev_b32 v5, 2, v5
    v_mov_b32 v6, v64
    v_cmp_eq_u32 vcc, 1, v4
    v_xor_b32 v7, 2048, v112
    s_nop 0
    v_cndmask_b32 v6, v6, v65, vcc
    v_cmp_eq_u32 vcc, 2, v4
    v_xor_b32 v8, 4096, v112
    s_nop 0
    v_cndmask_b32 v6, v6, v66, vcc
    v_cmp_eq_u32 vcc, 3, v4
    v_xor_b32 v9, 6144, v112
    s_nop 0
    v_cndmask_b32 v6, v6, v67, vcc
    ds_write_b128 v112, v[68:71]
    ds_bpermute_b32 v64, v5, v6
    s_lshr_b32 s65, s60, 1
    s_lshl_b32 s65, s65, 10
    s_add_u32 s65, s65, s11
    s_xor_b32 s66, s65, 1024
    s_waitcnt lgkmcnt(0)
    s_barrier
    ds_read_b128 v[84:87], v7
    ds_read_b128 v[88:91], v8
    ds_read_b128 v[92:95], v9
    buffer_load_dwordx4 v22, s[40:43], s93 offen offset:1024 lds
    s_waitcnt vmcnt(10)
POLL_1:
    v_xor_b32 v1, s5, v1
    v_cmp_lt_u32 vcc, 15, v1
    s_nop 0
    s_cbranch_vccz POLL_1_d
    s_cmp_eq_u32 s78, 0
    s_cbranch_scc1 POLL_1_d
    s_sub_u32 s78, s78, 1
HOP16:
    s_cbranch_execz HOP_RET
    s_sleep 1
    buffer_load_dword v1, v20, s[56:59], s73 offen offset:0 sc1
    s_waitcnt vmcnt(0)
    s_branch POLL_1
POLL_1_d:
    v_cmp_ne_u32 vcc, 0, v1
    v_mov_b32 v21, s63
    s_cmp_eq_u64 vcc, 0
    s_cselect_b32 s13, 1, 0
    v_mul_f32 v60, 0x3b000000, v60
    v_mul_f32 v64, 0x3b000000, v64
    v_fma_f32 v64, -v60, v60, v64
    v_max_f32 v64, 0, v64
    v_add_f32 v64, 0x3727c5ac, v64
    v_sub_f32 v80, 0, v60
    v_rsq_f32 v60, v64
    s_nop 0
    v_mul_f32 v83, v64, v60
    v_mul_f32 v81, 0xc0135761, v60
    v_mul_f32 v64, v60, v60
    v_mul_f32 v64, 0x3d372713, v64
    v_mul_f32 v82, v64, v81
    v_mov_b32 v4, 0x7f7fffff
    v_cndmask_b32 v83, v83, v4, s[14:15]
    s_add_u32 m0, s69, 122880
    s_add_u32 s93, s93, 0x10000
    s_and_b32 s93, s93, 0x7ffff
    buffer_load_dwordx4 v35, s[40:43], s93 offen lds
    s_waitcnt lgkmcnt(0)
    v_pk_fma_f32 v[44:45], v[68:69], v[80:81], v[44:45] op_sel:[0,0,0] op_sel_hi:[1,0,1]
    v_pk_fma_f32 v[46:47], v[70:71], v[80:81], v[46:47] op_sel:[0,0,0] op_sel_hi:[1,0,1]
    v_pk_fma_f32 v[48:49], v[84:85], v[80:81], v[48:49] op_sel:[0,0,0] op_sel_hi:[1,0,1]
    v_pk_fma_f32 v[50:51], v[86:87], v[80:81], v[50:51] op_sel:[0,0,0] op_sel_hi:[1,0,1]
    v_pk_fma_f32 v[52:53], v[88:89], v[80:81], v[52:53] op_sel:[0,0,0] op_sel_hi:[1,0,1]
    v_pk_fma_f32 v[54:55], v[90:91], v[80:81], v[54:55] op_sel:[0,0,0] op_sel_hi:[1,0,1]
    v_pk_fma_f32 v[56:57], v[92:93], v[80:81], v[56:57] op_sel:[0,0,0] op_sel_hi:[1,0,1]
    v_pk_fma_f32 v[58:59], v[94:95], v[80:81], v[58:59] op_sel:[0,0,0] op_sel_hi:[1,0,1]
    buffer_load_dwordx4 v22, s[40:43], s93 offen offset:1024 lds
    v_pk_mul_f32 v[96:97], v[44:45], v[44:45]
HOP17:
    s_cbranch_execz HOP_RET
    v_pk_mul_f32 v[98:99], v[46:47], v[46:47]
    v_pk_mul_f32 v[100:101], v[48:49], v[48:49]
    v_pk_mul_f32 v[102:103], v[50:51], v[50:51]
    v_pk_mul_f32 v[104:105], v[52:53], v[52:53]
    v_pk_mul_f32 v[106:107], v[54:55], v[54:55]
    v_pk_mul_f32 v[108:109], v[56:57], v[56:57]
    v_pk_mul_f32 v[110:111], v[58:59], v[58:59]
    s_add_u32 m0, s75, 0
    s_nop 0
    buffer_load_dwordx4 v23, s[32:35], 0 offen lds
    v_pk_fma_f32 v[96:97], v[96:97], v[82:83], v[80:81] op_sel:[0,0,1] op_sel_hi:[1,0,1]
    v_pk_fma_f32 v[98:99], v[98:99], v[82:83], v[80:81] op_sel:[0,0,1] op_sel_hi:[1,0,1]
    v_pk_fma_f32 v[100:101], v[100:101], v[82:83], v[80:81] op_sel:[0,0,1] op_sel_hi:[1,0,1]
    v_pk_fma_f32 v[102:103], v[102:103], v[82:83], v[80:81] op_sel:[0,0,1] op_sel_hi:[1,0,1]
    v_pk_fma_f32 v[104:105], v[104:105], v[82:83], v[80:81] op_sel:[0,0,1] op_sel_hi:[1,0,1]
    v_pk_fma_f32 v[106:107], v[106:107], v[82:83], v[80:81] op_sel:[0,0,1] op_sel_hi:[1,0,1]
    v_pk_fma_f32 v[108:109], v[108:109], v[82:83], v[80:81] op_sel:[0,0,1] op_sel_hi:[1,0,1]
    v_pk_fma_f32 v[110:111], v[110:111], v[82:83], v[80:81] op_sel:[0,0,1] op_sel_hi:[1,0,1]
    buffer_load_dwordx4 v113, s[32:35], 0 offen offset:1024 lds
    v_pk_mul_f32 v[96:97], v[96:97], v[44:45]
    v_pk_mul_f32 v[98:99], v[98:99], v[46:47]
    v_pk_mul_f32 v[100:101], v[100:101], v[48:49]
    v_pk_mul_f32 v[102:103], v[102:103], v[50:51]
    v_pk_mul_f32 v[104:105], v[104:105], v[52:53]
    v_pk_mul_f32 v[106:107], v[106:107], v[54:55]
    v_pk_mul_f32 v[108:109], v[108:109], v[56:57]
    v_pk_mul_f32 v[110:111], v[110:111], v[58:59]
    s_add_u32 m0, s75, 2048
    s_nop 0
    buffer_load_dwordx4 v11, s[44:47], s79 offen lds
    v_exp_f32 v96, v96
    v_exp_f32 v97, v97
    v_exp_f32 v98, v98
    v_exp_f32 v99, v99
HOP18:
    s_cbranch_execz HOP_RET
    v_exp_f32 v100, v100
    v_exp_f32 v101, v101
    v_exp_f32 v102, v102
    v_exp_f32 v103, v103
    buffer_load_dwordx4 v12, s[44:47], s79 offen offset:1024 lds
    v_exp_f32 v104, v104
    v_exp_f32 v105, v105
    v_exp_f32 v106, v106
    v_exp_f32 v107, v107
    v_exp_f32 v108, v108
    v_exp_f32 v109, v109
    v_exp_f32 v110, v110
    v_exp_f32 v111, v111
    s_add_u32 m0, s75, 4096
    s_add_u32 s79, s79, 28672
    buffer_load_dwordx4 v11, s[44:47], s79 offen lds
    s_nop 0
    v_pk_fma_f32 v[96:97], v[96:97], v[82:83], v[82:83] op_sel:[0,1,1] op_sel_hi:[1,1,1]
    v_pk_fma_f32 v[98:99], v[98:99], v[82:83], v[82:83] op_sel:[0,1,1] op_sel_hi:[1,1,1]
    v_pk_fma_f32 v[100:101], v[100:101], v[82:83], v[82:83] op_sel:[0,1,1] op_sel_hi:[1,1,1]
    v_pk_fma_f32 v[102:103], v[102:103], v[82:83], v[82:83] op_sel:[0,1,1] op_sel_hi:[1,1,1]
    v_pk_fma_f32 v[104:105], v[104:105], v[82:83], v[82:83] op_sel:[0,1,1] op_sel_hi:[1,1,1]
    v_pk_fma_f32 v[106:107], v[106:107], v[82:83], v[82:83] op_sel:[0,1,1] op_sel_hi:[1,1,1]
    v_pk_fma_f32 v[108:109], v[108:109], v[82:83], v[82:83] op_sel:[0,1,1] op_sel_hi:[1,1,1]
    v_pk_fma_f32 v[110:111], v[110:111], v[82:83], v[82:83] op_sel:[0,1,1] op_sel_hi:[1,1,1]
    buffer_load_dwordx4 v12, s[44:47], s79 offen offset:1024 lds
    v_rcp_f32 v96, v96
    v_rcp_f32 v97, v97
    v_rcp_f32 v98, v98
    v_rcp_f32 v99, v99
    v_rcp_f32 v100, v100
    v_rcp_f32 v101, v101
    v_rcp_f32 v102, v102
    v_rcp_f32 v103, v103
    v_rcp_f32 v104, v104
    v_rcp_f32 v105, v105
    v_rcp_f32 v106, v106
    v_rcp_f32 v107, v107
    v_rcp_f32 v108, v108
    v_rcp_f32 v109, v109
    v_rcp_f32 v110, v110
    v_rcp_f32 v111, v111
    s_nop 0
    v_pk_mul_f32 v[44:45], v[44:45], v[96:97]
    v_pk_mul_f32 v[46:47], v[46:47], v[98:99]
    v_pk_mul_f32 v[48:49], v[48:49], v[100:101]
HOP19:
    s_cbranch_execz HOP_RET
    v_pk_mul_f32 v[50:51], v[50:51], v[102:103]
    v_pk_mul_f32 v[52:53], v[52:53], v[104:105]
    v_pk_mul_f32 v[54:55], v[54:55], v[106:107]
    v_pk_mul_f32 v[56:57], v[56:57], v[108:109]
    v_pk_mul_f32 v[58:59], v[58:59], v[110:111]
    v_cvt_pk_bf16_f32 v44, v44, v45
    v_cvt_pk_bf16_f32 v45, v46, v47
    v_cvt_pk_bf16_f32 v46, v48, v49
    v_cvt_pk_bf16_f32 v47, v50, v51
    v_cvt_pk_bf16_f32 v48, v52, v53
    v_cvt_pk_bf16_f32 v49, v54, v55
    v_cvt_pk_bf16_f32 v50, v56, v57
    v_cvt_pk_bf16_f32 v51, v58, v59
    s_cmp_eq_u32 s13, 0
    s_cbranch_scc1 XS_2
    buffer_store_dwordx4 v[44:47], v10, s[56:59], s65 offen
    buffer_store_dwordx4 v[48:51], v10, s[56:59], s66 offen
XS_2_r:
    s_add_u32 m0, s74, 0
    s_add_u32 s79, s79, 86016
    buffer_load_dwordx4 v11, s[44:47], s79 offen lds
    buffer_load_dwordx4 v12, s[44:47], s79 offen offset:1024 lds
    s_add_u32 m0, s74, 2048
    s_add_u32 s79, s79, 28672
    buffer_load_dwordx4 v11, s[44:47], s79 offen lds
    buffer_load_dwordx4 v12, s[44:47], s79 offen offset:1024 lds
    s_add_u32 m0, s74, 4096
    s_add_u32 s79, s79, 86016
    s_cmp_eq_u32 s79, 1835008
    s_cselect_b32 s79, 0, s79
    buffer_load_dwordx4 v11, s[44:47], s79 offen lds
    buffer_load_dwordx4 v12, s[44:47], s79 offen offset:1024 lds
    v_lshrrev_b32 v4, 2, v2
    v_and_b32 v5, 3, v2
    v_lshl_add_u32 v6, v3, 2, v4
HOP20:
    s_cbranch_execz HOP_RET
    v_bfe_u32 v8, v6, 1, 2
    v_lshlrev_b32 v6, 7, v6
    v_lshl_add_u32 v6, v5, 3, v6
    s_and_b32 s65, s60, 1
    s_lshl_b32 s65, s65, 11
    s_add_u32 s65, s65, 65536
    v_add_u32 v6, s65, v6
    v_xor_b32 v9, 0, v8
    v_lshl_add_u32 v36, v9, 5, v6
    v_xor_b32 v37, 0x800, v36
    v_xor_b32 v9, 1, v8
    v_lshl_add_u32 v38, v9, 5, v6
    v_xor_b32 v39, 0x800, v38
    v_xor_b32 v9, 2, v8
    v_lshl_add_u32 v40, v9, 5, v6
    v_xor_b32 v41, 0x800, v40
    v_xor_b32 v9, 3, v8
    v_lshl_add_u32 v42, v9, 5, v6
    v_xor_b32 v43, 0x800, v42
    v_lshrrev_b32 v4, 1, v2
    v_lshrrev_b32 v5, 1, v3
    v_xor_b32 v4, v4, v5
    v_and_b32 v5, 1, v3
    v_lshlrev_b32 v5, 3, v5
    v_lshl_add_u32 v4, v4, 4, v5
    v_lshl_add_u32 v4, v2, 7, v4
    v_add_u32 v4, s75, v4
    v_xor_b32 v5, 32, v4
    v_xor_b32 v6, 64, v4
    v_xor_b32 v7, 96, v4
    s_waitcnt vmcnt(12)
    s_barrier
    ds_read_b64 v[72:73], v4
    ds_read_b64 v[74:75], v5
    ds_read_b64 v[76:77], v6
    ds_read_b64 v[78:79], v7
    ds_read_b64_tr_b16 v[192:193], v36 offset:0
    ds_read_b64_tr_b16 v[194:195], v37 offset:0
    ds_read_b64_tr_b16 v[196:197], v38 offset:0
    ds_read_b64_tr_b16 v[198:199], v39 offset:0
HOP21:
    s_cbranch_execz HOP_RET
    ds_read_b64_tr_b16 v[200:201], v40 offset:0
    ds_read_b64_tr_b16 v[202:203], v41 offset:0
    ds_read_b64_tr_b16 v[204:205], v42 offset:0
    ds_read_b64_tr_b16 v[206:207], v43 offset:0
    ds_read_b64_tr_b16 v[208:209], v36 offset:4096
    ds_read_b64_tr_b16 v[210:211], v37 offset:4096
    ds_read_b64_tr_b16 v[212:213], v38 offset:4096
    ds_read_b64_tr_b16 v[214:215], v39 offset:4096
    ds_read_b64_tr_b16 v[216:217], v40 offset:4096
    ds_read_b64_tr_b16 v[218:219], v41 offset:4096
    ds_read_b64_tr_b16 v[220:221], v42 offset:4096
    ds_read_b64_tr_b16 v[222:223], v43 offset:4096
    s_lshl_b32 s91, s64, 11
    s_add_u32 s92, s91, s71
    buffer_load_dwordx4 v[120:123], v10, s[56:59], s92 offen offset:0 sc1
    buffer_load_dwordx4 v[124:127], v10, s[56:59], s92 offen offset:1024 sc1
    ds_read_b64_tr_b16 v[224:225], v36 offset:8192
    ds_read_b64_tr_b16 v[226:227], v37 offset:8192
    ds_read_b64_tr_b16 v[228:229], v38 offset:8192
    ds_read_b64_tr_b16 v[230:231], v39 offset:8192
    ds_read_b64_tr_b16 v[232:233], v40 offset:8192
    ds_read_b64_tr_b16 v[234:235], v41 offset:8192
    ds_read_b64_tr_b16 v[236:237], v42 offset:8192
    ds_read_b64_tr_b16 v[238:239], v43 offset:8192
    s_add_u32 s91, s91, 2048
    s_and_b32 s91, s91, 0x3fff
    s_add_u32 s92, s91, s71
    buffer_load_dwordx4 v[128:131], v10, s[56:59], s92 offen offset:0 sc1
    buffer_load_dwordx4 v[132:135], v10, s[56:59], s92 offen offset:1024 sc1
    ds_read_b64_tr_b16 v[240:241], v36 offset:12288
    ds_read_b64_tr_b16 v[242:243], v37 offset:12288
    ds_read_b64_tr_b16 v[244:245], v38 offset:12288
HOP22:
    s_cbranch_execz HOP_RET
    ds_read_b64_tr_b16 v[246:247], v39 offset:12288
    ds_read_b64_tr_b16 v[248:249], v40 offset:12288
    ds_read_b64_tr_b16 v[250:251], v41 offset:12288
    ds_read_b64_tr_b16 v[252:253], v42 offset:12288
    ds_read_b64_tr_b16 v[254:255], v43 offset:12288
    s_add_u32 s91, s91, 2048
    s_and_b32 s91, s91, 0x3fff
    s_add_u32 s92, s91, s71
    buffer_load_dwordx4 v[136:139], v10, s[56:59], s92 offen offset:0 sc1
    buffer_load_dwordx4 v[140:143], v10, s[56:59], s92 offen offset:1024 sc1
    ds_read_b64_tr_b16 v[80:81], v36 offset:16384
    ds_read_b64_tr_b16 v[82:83], v37 offset:16384
    ds_read_b64_tr_b16 v[84:85], v38 offset:16384
    ds_read_b64_tr_b16 v[86:87], v39 offset:16384
    ds_read_b64_tr_b16 v[88:89], v40 offset:16384
    ds_read_b64_tr_b16 v[90:91], v41 offset:16384
    ds_read_b64_tr_b16 v[92:93], v42 offset:16384
    ds_read_b64_tr_b16 v[94:95], v43 offset:16384
    s_add_u32 s91, s91, 2048
    s_and_b32 s91, s91, 0x3fff
    s_add_u32 s92, s91, s71
    buffer_load_dwordx4 v[144:147], v10, s[56:59], s92 offen offset:0 sc1
    buffer_load_dwordx4 v[148:151], v10, s[56:59], s92 offen offset:1024 sc1
    ds_read_b64_tr_b16 v[96:97], v36 offset:20480
    ds_read_b64_tr_b16 v[98:99], v37 offset:20480
    ds_read_b64_tr_b16 v[100:101], v38 offset:20480
    ds_read_b64_tr_b16 v[102:103], v39 offset:20480
    ds_read_b64_tr_b16 v[104:105], v40 offset:20480
    ds_read_b64_tr_b16 v[106:107], v41 offset:20480
    ds_read_b64_tr_b16 v[108:109], v42 offset:20480
    ds_read_b64_tr_b16 v[110:111], v43 offset:20480
    s_waitcnt vmcnt(6)
HOP23:
    s_cbranch_execz HOP_RET
CK_3:
    v_max3_u32 v1, v120, v121, v122
    v_max3_u32 v1, v1, v123, v124
    v_max3_u32 v1, v1, v125, v126
    v_max_u32 v1, v1, v127
    v_cmp_eq_u32 vcc, -1, v1
    s_nop 0
    s_cbranch_vccz CK_3_ok
    s_cmp_eq_u32 s78, 0
    s_cbranch_scc1 CK_3_ok
    s_sub_u32 s78, s78, 1
    s_sleep 1
    s_add_u32 s4, s64, 0
    s_and_b32 s4, s4, 7
    s_lshl_b32 s4, s4, 11
    s_add_u32 s4, s4, s71
    buffer_load_dwordx4 v[120:123], v10, s[56:59], s4 offen offset:0 sc1
    buffer_load_dwordx4 v[124:127], v10, s[56:59], s4 offen offset:1024 sc1
    s_waitcnt vmcnt(0)
    s_branch CK_3
CK_3_ok:
    s_waitcnt lgkmcnt(15)
    v_mfma_f32_16x16x32_bf16 v[44:47], v[192:195], v[120:123], 0
    v_mfma_f32_16x16x32_bf16 v[48:51], v[196:199], v[120:123], 0
    s_add_u32 s91, s91, 2048
    s_and_b32 s91, s91, 0x3fff
    s_add_u32 s92, s91, s71
    buffer_load_dwordx4 v[152:155], v10, s[56:59], s92 offen offset:0 sc1
    v_mfma_f32_16x16x32_bf16 v[52:55], v[200:203], v[120:123], 0
    v_mfma_f32_16x16x32_bf16 v[56:59], v[204:207], v[120:123], 0
    v_mfma_f32_16x16x32_bf16 v[44:47], v[208:211], v[124:127], v[44:47]
    ds_read_b64_tr_b16 v[192:193], v36 offset:24576
    ds_read_b64_tr_b16 v[194:195], v37 offset:24576
    v_mfma_f32_16x16x32_bf16 v[48:51], v[212:215], v[124:127], v[48:51]
    ds_read_b64_tr_b16 v[196:197], v38 offset:24576
    ds_read_b64_tr_b16 v[198:199], v39 offset:24576
    buffer_load_dwordx4 v[156:159], v10, s[56:59], s92 offen offset:1024 sc1
    v_mfma_f32_16x16x32_bf16 v[52:55], v[216:219], v[124:127], v[52:55]
    ds_read_b64_tr_b16 v[200:201], v40 offset:24576
    ds_read_b64_tr_b16 v[202:203], v41 offset:24576
    v_mfma_f32_16x16x32_bf16 v[56:59], v[220:223], v[124:127], v[56:59]
HOP24:
    s_cbranch_execz HOP_RET
    ds_read_b64_tr_b16 v[204:205], v42 offset:24576
    ds_read_b64_tr_b16 v[206:207], v43 offset:24576
    s_waitcnt vmcnt(6)
CK_4:
    v_max3_u32 v1, v128, v129, v130
    v_max3_u32 v1, v1, v131, v132
    v_max3_u32 v1, v1, v133, v134
    v_max_u32 v1, v1, v135
    v_cmp_eq_u32 vcc, -1, v1
    s_nop 0
    s_cbranch_vccz CK_4_ok
    s_cmp_eq_u32 s78, 0
    s_cbranch_scc1 CK_4_ok
    s_sub_u32 s78, s78, 1
    s_sleep 1
    s_add_u32 s4, s64, 1
    s_and_b32 s4, s4, 7
    s_lshl_b32 s4, s4, 11
    s_add_u32 s4, s4, s71
    buffer_load_dwordx4 v[128:131], v10, s[56:59], s4 offen offset:0 sc1
    buffer_load_dwordx4 v[132:135], v10, s[56:59], s4 offen offset:1024 sc1
    s_waitcnt vmcnt(0)
    s_branch CK_4
CK_4_ok:
    v_mfma_f32_16x16x32_bf16 v[44:47], v[224:227], v[128:131], v[44:47]
    ds_read_b64_tr_b16 v[208:209], v36 offset:28672
    ds_read_b64_tr_b16 v[210:211], v37 offset:28672
    v_mfma_f32_16x16x32_bf16 v[48:51], v[228:231], v[128:131], v[48:51]
    ds_read_b64_tr_b16 v[212:213], v38 offset:28672
    ds_read_b64_tr_b16 v[214:215], v39 offset:28672
    s_add_u32 s91, s91, 2048
    s_and_b32 s91, s91, 0x3fff
    s_add_u32 s92, s91, s71
    buffer_load_dwordx4 v[160:163], v10, s[56:59], s92 offen offset:0 sc1
    v_mfma_f32_16x16x32_bf16 v[52:55], v[232:235], v[128:131], v[52:55]
    ds_read_b64_tr_b16 v[216:217], v40 offset:28672
    ds_read_b64_tr_b16 v[218:219], v41 offset:28672
    v_mfma_f32_16x16x32_bf16 v[56:59], v[236:239], v[128:131], v[56:59]
    ds_read_b64_tr_b16 v[220:221], v42 offset:28672
    ds_read_b64_tr_b16 v[222:223], v43 offset:28672
    v_mfma_f32_16x16x32_bf16 v[44:47], v[240:243], v[132:135], v[44:47]
HOP25:
    s_cbranch_execz HOP_RET
    ds_read_b64_tr_b16 v[224:225], v36 offset:32768
    ds_read_b64_tr_b16 v[226:227], v37 offset:32768
    v_mfma_f32_16x16x32_bf16 v[48:51], v[244:247], v[132:135], v[48:51]
    ds_read_b64_tr_b16 v[228:229], v38 offset:32768
    ds_read_b64_tr_b16 v[230:231], v39 offset:32768
    buffer_load_dwordx4 v[164:167], v10, s[56:59], s92 offen offset:1024 sc1
    v_mfma_f32_16x16x32_bf16 v[52:55], v[248:251], v[132:135], v[52:55]
    ds_read_b64_tr_b16 v[232:233], v40 offset:32768
    ds_read_b64_tr_b16 v[234:235], v41 offset:32768
    v_mfma_f32_16x16x32_bf16 v[56:59], v[252:255], v[132:135], v[56:59]
    ds_read_b64_tr_b16 v[236:237], v42 offset:32768
    ds_read_b64_tr_b16 v[238:239], v43 offset:32768
    s_waitcnt vmcnt(6)
CK_5:
    v_max3_u32 v1, v136, v137, v138
    v_max3_u32 v1, v1, v139, v140
    v_max3_u32 v1, v1, v141, v142
    v_max_u32 v1, v1, v143
    v_cmp_eq_u32 vcc, -1, v1
    s_nop 0
    s_cbranch_vccz CK_5_ok
    s_cmp_eq_u32 s78, 0
    s_cbranch_scc1 CK_5_ok
    s_sub_u32 s78, s78, 1
    s_sleep 1
    s_add_u32 s4, s64, 2
    s_and_b32 s4, s4, 7
    s_lshl_b32 s4, s4, 11
    s_add_u32 s4, s4, s71
    buffer_load_dwordx4 v[136:139], v10, s[56:59], s4 offen offset:0 sc1
    buffer_load_dwordx4 v[140:143], v10, s[56:59], s4 offen offset:1024 sc1
    s_waitcnt vmcnt(0)
    s_branch CK_5
CK_5_ok:
    s_waitcnt lgkmcnt(15)
    v_mfma_f32_16x16x32_bf16 v[44:47], v[80:83], v[136:139], v[44:47]
    ds_read_b64_tr_b16 v[240:241], v36 offset:36864
    ds_read_b64_tr_b16 v[242:243], v37 offset:36864
    v_mfma_f32_16x16x32_bf16 v[48:51], v[84:87], v[136:139], v[48:51]
    ds_read_b64_tr_b16 v[244:245], v38 offset:36864
    ds_read_b64_tr_b16 v[246:247], v39 offset:36864
HOP26:
    s_cbranch_execz HOP_RET
    s_add_u32 s91, s91, 2048
    s_and_b32 s91, s91, 0x3fff
    s_add_u32 s92, s91, s71
    buffer_load_dwordx4 v[168:171], v10, s[56:59], s92 offen offset:0 sc1
    v_mfma_f32_16x16x32_bf16 v[52:55], v[88:91], v[136:139], v[52:55]
    ds_read_b64_tr_b16 v[248:249], v40 offset:36864
    ds_read_b64_tr_b16 v[250:251], v41 offset:36864
    v_mfma_f32_16x16x32_bf16 v[56:59], v[92:95], v[136:139], v[56:59]
    ds_read_b64_tr_b16 v[252:253], v42 offset:36864
    ds_read_b64_tr_b16 v[254:255], v43 offset:36864
    v_mfma_f32_16x16x32_bf16 v[44:47], v[96:99], v[140:143], v[44:47]
    ds_read_b64_tr_b16 v[80:81], v36 offset:40960
    ds_read_b64_tr_b16 v[82:83], v37 offset:40960
    v_mfma_f32_16x16x32_bf16 v[48:51], v[100:103], v[140:143], v[48:51]
    ds_read_b64_tr_b16 v[84:85], v38 offset:40960
    ds_read_b64_tr_b16 v[86:87], v39 offset:40960
    buffer_load_dwordx4 v[172:175], v10, s[56:59], s92 offen offset:1024 sc1
    v_mfma_f32_16x16x32_bf16 v[52:55], v[104:107], v[140:143], v[52:55]
    ds_read_b64_tr_b16 v[88:89], v40 offset:40960
    ds_read_b64_tr_b16 v[90:91], v41 offset:40960
    v_mfma_f32_16x16x32_bf16 v[56:59], v[108:111], v[140:143], v[56:59]
    ds_read_b64_tr_b16 v[92:93], v42 offset:40960
    ds_read_b64_tr_b16 v[94:95], v43 offset:40960
    s_waitcnt vmcnt(6)
CK_6:
    v_max3_u32 v1, v144, v145, v146
    v_max3_u32 v1, v1, v147, v148
    v_max3_u32 v1, v1, v149, v150
    v_max_u32 v1, v1, v151
    v_cmp_eq_u32 vcc, -1, v1
    s_nop 0
    s_cbranch_vccz CK_6_ok
    s_cmp_eq_u32 s78, 0
    s_cbranch_scc1 CK_6_ok
    s_sub_u32 s78, s78, 1
    s_sleep 1
    s_add_u32 s4, s64, 3
HOP27:
    s_cbranch_execz HOP_RET
    s_and_b32 s4, s4, 7
    s_lshl_b32 s4, s4, 11
    s_add_u32 s4, s4, s71
    buffer_load_dwordx4 v[144:147], v10, s[56:59], s4 offen offset:0 sc1
    buffer_load_dwordx4 v[148:151], v10, s[56:59], s4 offen offset:1024 sc1
    s_waitcnt vmcnt(0)
    s_branch CK_6
CK_6_ok:
    v_mfma_f32_16x16x32_bf16 v[44:47], v[192:195], v[144:147], v[44:47]
    ds_read_b64_tr_b16 v[96:97], v36 offset:45056
    ds_read_b64_tr_b16 v[98:99], v37 offset:45056
    v_mfma_f32_16x16x32_bf16 v[48:51], v[196:199], v[144:147], v[48:51]
    ds_read_b64_tr_b16 v[100:101], v38 offset:45056
    ds_read_b64_tr_b16 v[102:103], v39 offset:45056
    s_add_u32 s91, s91, 2048
    s_and_b32 s91, s91, 0x3fff
    s_add_u32 s92, s91, s71
    buffer_load_dwordx4 v[176:179], v10, s[56:59], s92 offen offset:0 sc1
    v_mfma_f32_16x16x32_bf16 v[52:55], v[200:203], v[144:147], v[52:55]
    ds_read_b64_tr_b16 v[104:105], v40 offset:45056
    ds_read_b64_tr_b16 v[106:107], v41 offset:45056
    v_mfma_f32_16x16x32_bf16 v[56:59], v[204:207], v[144:147], v[56:59]
    ds_read_b64_tr_b16 v[108:109], v42 offset:45056
    ds_read_b64_tr_b16 v[110:111], v43 offset:45056
    s_waitcnt lgkmcnt(15)
    v_mfma_f32_16x16x32_bf16 v[44:47], v[208:211], v[148:151], v[44:47]
    ds_read_b64_tr_b16 v[192:193], v36 offset:49152
    ds_read_b64_tr_b16 v[194:195], v37 offset:49152
    v_mfma_f32_16x16x32_bf16 v[48:51], v[212:215], v[148:151], v[48:51]
    ds_read_b64_tr_b16 v[196:197], v38 offset:49152
    ds_read_b64_tr_b16 v[198:199], v39 offset:49152
    buffer_load_dwordx4 v[180:183], v10, s[56:59], s92 offen offset:1024 sc1
    v_mfma_f32_16x16x32_bf16 v[52:55], v[216:219], v[148:151], v[52:55]
    ds_read_b64_tr_b16 v[200:201], v40 offset:49152
    ds_read_b64_tr_b16 v[202:203], v41 offset:49152
HOP28:
    s_cbranch_execz HOP_RET
    v_mfma_f32_16x16x32_bf16 v[56:59], v[220:223], v[148:151], v[56:59]
    ds_read_b64_tr_b16 v[204:205], v42 offset:49152
    ds_read_b64_tr_b16 v[206:207], v43 offset:49152
    s_waitcnt vmcnt(6)
CK_7:
    v_max3_u32 v1, v152, v153, v154
    v_max3_u32 v1, v1, v155, v156
    v_max3_u32 v1, v1, v157, v158
    v_max_u32 v1, v1, v159
    v_cmp_eq_u32 vcc, -1, v1
    s_nop 0
    s_cbranch_vccz CK_7_ok
    s_cmp_eq_u32 s78, 0
    s_cbranch_scc1 CK_7_ok
    s_sub_u32 s78, s78, 1
    s_sleep 1
    s_add_u32 s4, s64, 4
    s_and_b32 s4, s4, 7
    s_lshl_b32 s4, s4, 11
    s_add_u32 s4, s4, s71
    buffer_load_dwordx4 v[152:155], v10, s[56:59], s4 offen offset:0 sc1
    buffer_load_dwordx4 v[156:159], v10, s[56:59], s4 offen offset:1024 sc1
    s_waitcnt vmcnt(0)
    s_branch CK_7
CK_7_ok:
    v_mfma_f32_16x16x32_bf16 v[44:47], v[224:227], v[152:155], v[44:47]
    ds_read_b64_tr_b16 v[208:209], v36 offset:53248
    ds_read_b64_tr_b16 v[210:211], v37 offset:53248
    v_mfma_f32_16x16x32_bf16 v[48:51], v[228:231], v[152:155], v[48:51]
    ds_read_b64_tr_b16 v[212:213], v38 offset:53248
    ds_read_b64_tr_b16 v[214:215], v39 offset:53248
    s_add_u32 m0, s74, 6144
    s_add_u32 s79, s79, 28672
    buffer_load_dwordx4 v11, s[44:47], s79 offen lds
    v_mfma_f32_16x16x32_bf16 v[52:55], v[232:235], v[152:155], v[52:55]
    ds_read_b64_tr_b16 v[216:217], v40 offset:53248
    ds_read_b64_tr_b16 v[218:219], v41 offset:53248
    v_mfma_f32_16x16x32_bf16 v[56:59], v[236:239], v[152:155], v[56:59]
    ds_read_b64_tr_b16 v[220:221], v42 offset:53248
    ds_read_b64_tr_b16 v[222:223], v43 offset:53248
HOP29:
    s_cbranch_execz HOP_RET
    v_mfma_f32_16x16x32_bf16 v[44:47], v[240:243], v[156:159], v[44:47]
    ds_read_b64_tr_b16 v[224:225], v36 offset:57344
    ds_read_b64_tr_b16 v[226:227], v37 offset:57344
    v_mfma_f32_16x16x32_bf16 v[48:51], v[244:247], v[156:159], v[48:51]
    ds_read_b64_tr_b16 v[228:229], v38 offset:57344
    ds_read_b64_tr_b16 v[230:231], v39 offset:57344
    buffer_load_dwordx4 v12, s[44:47], s79 offen offset:1024 lds
    v_mfma_f32_16x16x32_bf16 v[52:55], v[248:251], v[156:159], v[52:55]
    ds_read_b64_tr_b16 v[232:233], v40 offset:57344
    ds_read_b64_tr_b16 v[234:235], v41 offset:57344
    v_mfma_f32_16x16x32_bf16 v[56:59], v[252:255], v[156:159], v[56:59]
    ds_read_b64_tr_b16 v[236:237], v42 offset:57344
    ds_read_b64_tr_b16 v[238:239], v43 offset:57344
    s_waitcnt vmcnt(6)
CK_8:
    v_max3_u32 v1, v160, v161, v162
    v_max3_u32 v1, v1, v163, v164
    v_max3_u32 v1, v1, v165, v166
    v_max_u32 v1, v1, v167
    v_cmp_eq_u32 vcc, -1, v1
    s_nop 0
    s_cbranch_vccz CK_8_ok
    s_cmp_eq_u32 s78, 0
    s_cbranch_scc1 CK_8_ok
    s_sub_u32 s78, s78, 1
    s_sleep 1
    s_add_u32 s4, s64, 5
    s_and_b32 s4, s4, 7
    s_lshl_b32 s4, s4, 11
    s_add_u32 s4, s4, s71
    buffer_load_dwordx4 v[160:163], v10, s[56:59], s4 offen offset:0 sc1
    buffer_load_dwordx4 v[164:167], v10, s[56:59], s4 offen offset:1024 sc1
    s_waitcnt vmcnt(0)
    s_branch CK_8
CK_8_ok:
    s_waitcnt lgkmcnt(15)
    v_mfma_f32_16x16x32_bf16 v[44:47], v[80:83], v[160:163], v[44:47]
    ds_read_b64_tr_b16 v[240:241], v36 offset:61440
    ds_read_b64_tr_b16 v[242:243], v37 offset:61440
    v_mfma_f32_16x16x32_bf16 v[48:51], v[84:87], v[160:163], v[48:51]
    ds_read_b64_tr_b16 v[244:245], v38 offset:61440
HOP30:
    s_cbranch_execz HOP_RET
    ds_read_b64_tr_b16 v[246:247], v39 offset:61440
    s_add_u32 m0, s74, 8192
    s_add_u32 s79, s79, 86016
    buffer_load_dwordx4 v11, s[44:47], s79 offen lds
    v_mfma_f32_16x16x32_bf16 v[52:55], v[88:91], v[160:163], v[52:55]
    ds_read_b64_tr_b16 v[248:249], v40 offset:61440
    ds_read_b64_tr_b16 v[250:251], v41 offset:61440
    v_mfma_f32_16x16x32_bf16 v[56:59], v[92:95], v[160:163], v[56:59]
    ds_read_b64_tr_b16 v[252:253], v42 offset:61440
    ds_read_b64_tr_b16 v[254:255], v43 offset:61440
    v_mfma_f32_16x16x32_bf16 v[44:47], v[96:99], v[164:167], v[44:47]
    v_mfma_f32_16x16x32_bf16 v[48:51], v[100:103], v[164:167], v[48:51]
    buffer_load_dwordx4 v12, s[44:47], s79 offen offset:1024 lds
    v_mfma_f32_16x16x32_bf16 v[52:55], v[104:107], v[164:167], v[52:55]
    v_mfma_f32_16x16x32_bf16 v[56:59], v[108:111], v[164:167], v[56:59]
    s_waitcnt vmcnt(6)
CK_9:
    v_max3_u32 v1, v168, v169, v170
    v_max3_u32 v1, v1, v171, v172
    v_max3_u32 v1, v1, v173, v174
    v_max_u32 v1, v1, v175
    v_cmp_eq_u32 vcc, -1, v1
    s_nop 0
    s_cbranch_vccz CK_9_ok
    s_cmp_eq_u32 s78, 0
    s_cbranch_scc1 CK_9_ok
    s_sub_u32 s78, s78, 1
    s_sleep 1
    s_add_u32 s4, s64, 6
    s_and_b32 s4, s4, 7
    s_lshl_b32 s4, s4, 11
    s_add_u32 s4, s4, s71
    buffer_load_dwordx4 v[168:171], v10, s[56:59], s4 offen offset:0 sc1
    buffer_load_dwordx4 v[172:175], v10, s[56:59], s4 offen offset:1024 sc1
    s_waitcnt vmcnt(0)
    s_branch CK_9
CK_9_ok:
    v_mfma_f32_16x16x32_bf16 v[44:47], v[192:195], v[168:171], v[44:47]
    v_mfma_f32_16x16x32_bf16 v[48:51], v[196:199], v[168:171], v[48:51]
    s_add_u32 m0, s74, 10240
HOP31:
    s_cbranch_execz HOP_RET
    s_add_u32 s79, s79, 28672
    buffer_load_dwordx4 v11, s[44:47], s79 offen lds
    v_mfma_f32_16x16x32_bf16 v[52:55], v[200:203], v[168:171], v[52:55]
    v_mfma_f32_16x16x32_bf16 v[56:59], v[204:207], v[168:171], v[56:59]
    s_waitcnt lgkmcnt(15)
    v_mfma_f32_16x16x32_bf16 v[44:47], v[208:211], v[172:175], v[44:47]
    v_mfma_f32_16x16x32_bf16 v[48:51], v[212:215], v[172:175], v[48:51]
    buffer_load_dwordx4 v12, s[44:47], s79 offen offset:1024 lds
    v_mfma_f32_16x16x32_bf16 v[52:55], v[216:219], v[172:175], v[52:55]
    v_mfma_f32_16x16x32_bf16 v[56:59], v[220:223], v[172:175], v[56:59]
    s_waitcnt vmcnt(6)
CK_10:
    v_max3_u32 v1, v176, v177, v178
    v_max3_u32 v1, v1, v179, v180
    v_max3_u32 v1, v1, v181, v182
    v_max_u32 v1, v1, v183
    v_cmp_eq_u32 vcc, -1, v1
    s_nop 0
    s_cbranch_vccz CK_10_ok
    s_cmp_eq_u32 s78, 0
    s_cbranch_scc1 CK_10_ok
    s_sub_u32 s78, s78, 1
    s_sleep 1
    s_add_u32 s4, s64, 7
    s_and_b32 s4, s4, 7
    s_lshl_b32 s4, s4, 11
    s_add_u32 s4, s4, s71
    buffer_load_dwordx4 v[176:179], v10, s[56:59], s4 offen offset:0 sc1
    buffer_load_dwordx4 v[180:183], v10, s[56:59], s4 offen offset:1024 sc1
    s_waitcnt vmcnt(0)
    s_branch CK_10
CK_10_ok:
    s_waitcnt lgkmcnt(8)
    v_mfma_f32_16x16x32_bf16 v[44:47], v[224:227], v[176:179], v[44:47]
    v_mfma_f32_16x16x32_bf16 v[48:51], v[228:231], v[176:179], v[48:51]
    v_mfma_f32_16x16x32_bf16 v[52:55], v[232:235], v[176:179], v[52:55]
    v_mfma_f32_16x16x32_bf16 v[56:59], v[236:239], v[176:179], v[56:59]
    s_waitcnt lgkmcnt(0)
    v_mfma_f32_16x16x32_bf16 v[44:47], v[240:243], v[180:183], v[44:47]
    v_mfma_f32_16x16x32_bf16 v[48:51], v[244:247], v[180:183], v[48:51]
    v_mfma_f32_16x16x32_bf16 v[52:55], v[248:251], v[180:183], v[52:55]
    v_mfma_f32_16x16x32_bf16 v[56:59], v[252:255], v[180:183], v[56:59]
HOP32:
    s_cbranch_execz HOP_RET
    v_lshlrev_b32 v80, 16, v72
    v_and_b32 v81, 0xffff0000, v72
    v_lshlrev_b32 v82, 16, v73
    v_and_b32 v83, 0xffff0000, v73
    v_lshlrev_b32 v84, 16, v74
    v_and_b32 v85, 0xffff0000, v74
    v_lshlrev_b32 v86, 16, v75
    v_and_b32 v87, 0xffff0000, v75
    v_lshlrev_b32 v88, 16, v76
    v_and_b32 v89, 0xffff0000, v76
    v_lshlrev_b32 v90, 16, v77
    v_and_b32 v91, 0xffff0000, v77
    v_lshlrev_b32 v92, 16, v78
    v_and_b32 v93, 0xffff0000, v78
    v_lshlrev_b32 v94, 16, v79
    v_and_b32 v95, 0xffff0000, v79
    v_pk_add_f32 v[44:45], v[44:45], v[80:81]
    v_pk_add_f32 v[46:47], v[46:47], v[82:83]
    v_pk_add_f32 v[48:49], v[48:49], v[84:85]
    v_pk_add_f32 v[50:51], v[50:51], v[86:87]
    v_pk_add_f32 v[52:53], v[52:53], v[88:89]
    v_pk_add_f32 v[54:55], v[54:55], v[90:91]
    v_pk_add_f32 v[56:57], v[56:57], v[92:93]
    v_pk_add_f32 v[58:59], v[58:59], v[94:95]
    v_cvt_pk_bf16_f32 v44, v44, v45
    v_cvt_pk_bf16_f32 v45, v46, v47
    v_cvt_pk_bf16_f32 v46, v48, v49
    v_cvt_pk_bf16_f32 v47, v50, v51
    v_cvt_pk_bf16_f32 v48, v52, v53
    v_cvt_pk_bf16_f32 v49, v54, v55
    v_cvt_pk_bf16_f32 v50, v56, v57
    v_cvt_pk_bf16_f32 v51, v58, v59
    s_cmp_eq_u32 s13, 0
    s_cbranch_scc1 XS_11
    buffer_store_dwordx4 v[44:47], v10, s[56:59], s12 offen offset:0
    buffer_store_dwordx4 v[48:51], v10, s[56:59], s12 offen offset:1024
HOP33:
    s_cbranch_execz HOP_RET
XS_11_r:
    s_add_u32 s71, s71, 0x200000
    v_add_u32 v22, s74, v10
    s_barrier
    s_add_u32 m0, s75, 0
    s_add_u32 s79, s79, 86016
    s_cmp_eq_u32 s79, 1835008
    s_cselect_b32 s79, 0, s79
    buffer_load_dwordx4 v11, s[44:47], s79 offen lds
    buffer_load_dwordx4 v12, s[44:47], s79 offen offset:1024 lds
    s_add_u32 m0, s74, 65536
    s_add_u32 s79, s79, 28672
    buffer_load_dwordx4 v11, s[44:47], s79 offen lds
    buffer_load_dwordx4 v12, s[44:47], s79 offen offset:1024 lds
    s_add_u32 m0, s74, 67584
    s_add_u32 s79, s79, 86016
    buffer_load_dwordx4 v11, s[44:47], s79 offen lds
    buffer_load_dwordx4 v12, s[44:47], s79 offen offset:1024 lds
    ds_read_b64_tr_b16 a[0:1], v15 offset:2048
    ds_read_b64_tr_b16 a[2:3], v15 offset:3072
    ds_read_b64_tr_b16 a[4:5], v16 offset:2048
    ds_read_b64_tr_b16 a[6:7], v16 offset:3072
    ds_read_b64_tr_b16 a[8:9], v15 offset:4096
    ds_read_b64_tr_b16 a[10:11], v15 offset:5120
    ds_read_b64_tr_b16 a[12:13], v16 offset:4096
    ds_read_b64_tr_b16 a[14:15], v16 offset:5120
    s_add_u32 s81, s74, 0
    s_mov_b32 s70, s75
    s_sub_u32 s81, s81, s70
    v_add_u32 v15, s81, v15
    v_add_u32 v16, s81, v16
    ds_read_b64_tr_b16 a[16:17], v15 offset:0
    ds_read_b64_tr_b16 a[18:19], v15 offset:1024
    ds_read_b64_tr_b16 a[20:21], v16 offset:0
    ds_read_b64_tr_b16 a[22:23], v16 offset:1024
    ds_read_b64_tr_b16 a[24:25], v15 offset:2048
HOP34:
    s_cbranch_execz HOP_RET
    ds_read_b64_tr_b16 a[26:27], v15 offset:3072
    ds_read_b64_tr_b16 a[28:29], v16 offset:2048
    ds_read_b64_tr_b16 a[30:31], v16 offset:3072
    ds_read_b64_tr_b16 a[32:33], v15 offset:4096
    ds_read_b64_tr_b16 a[34:35], v15 offset:5120
    ds_read_b64_tr_b16 a[36:37], v16 offset:4096
    ds_read_b64_tr_b16 a[38:39], v16 offset:5120
    s_waitcnt vmcnt(12)
    ds_read_b64_tr_b16 a[40:41], v15 offset:6144
    ds_read_b64_tr_b16 a[42:43], v15 offset:7168
    ds_read_b64_tr_b16 a[44:45], v16 offset:6144
    ds_read_b64_tr_b16 a[46:47], v16 offset:7168
    s_waitcnt vmcnt(10)
    ds_read_b64_tr_b16 a[48:49], v15 offset:8192
    ds_read_b64_tr_b16 a[50:51], v15 offset:9216
    ds_read_b64_tr_b16 a[52:53], v16 offset:8192
    ds_read_b64_tr_b16 a[54:55], v16 offset:9216
    s_waitcnt vmcnt(8)
    ds_read_b64_tr_b16 a[56:57], v15 offset:10240
    ds_read_b64_tr_b16 a[58:59], v15 offset:11264
    ds_read_b64_tr_b16 a[60:61], v16 offset:10240
    ds_read_b64_tr_b16 a[62:63], v16 offset:11264
    s_waitcnt lgkmcnt(15)
    v_mfma_f32_16x16x32_bf16 v[184:187], a[0:3], v[28:31], 0
    v_mfma_f32_16x16x32_bf16 v[188:191], a[4:7], v[28:31], 0
    v_mfma_f32_16x16x32_bf16 v[184:187], a[8:11], v[28:31], v[184:187]
    v_mfma_f32_16x16x32_bf16 v[188:191], a[12:15], v[28:31], v[188:191]
    v_mfma_f32_16x16x32_bf16 v[184:187], a[16:19], v[28:31], v[184:187]
    v_mfma_f32_16x16x32_bf16 v[188:191], a[20:23], v[28:31], v[188:191]
    v_mfma_f32_16x16x32_bf16 v[184:187], a[24:27], v[28:31], v[184:187]
    v_mfma_f32_16x16x32_bf16 v[188:191], a[28:31], v[28:31], v[188:191]
    s_waitcnt lgkmcnt(12)
    v_mfma_f32_16x16x32_bf16 v[184:187], a[32:35], v[28:31], v[184:187]
HOP35:
    s_cbranch_execz HOP_RET
    v_mfma_f32_16x16x32_bf16 v[188:191], a[36:39], v[28:31], v[188:191]
    s_waitcnt lgkmcnt(8)
    v_mfma_f32_16x16x32_bf16 v[184:187], a[40:43], v[28:31], v[184:187]
    v_mfma_f32_16x16x32_bf16 v[188:191], a[44:47], v[28:31], v[188:191]
    s_waitcnt lgkmcnt(4)
    v_mfma_f32_16x16x32_bf16 v[184:187], a[48:51], v[28:31], v[184:187]
    v_mfma_f32_16x16x32_bf16 v[188:191], a[52:55], v[28:31], v[188:191]
    s_waitcnt lgkmcnt(0)
    v_mfma_f32_16x16x32_bf16 v[184:187], a[56:59], v[28:31], v[184:187]
    v_mfma_f32_16x16x32_bf16 v[188:191], a[60:63], v[28:31], v[188:191]
    s_lshl_b32 s91, s64, 11
    s_add_u32 s92, s91, s71
    buffer_load_dwordx4 v[120:123], v10, s[56:59], s92 offen offset:0 sc1
    buffer_load_dwordx4 v[124:127], v10, s[56:59], s92 offen offset:1024 sc1
    s_add_u32 s91, s91, 2048
    s_and_b32 s91, s91, 0x3fff
    s_add_u32 s92, s91, s71
    buffer_load_dwordx4 v[128:131], v10, s[56:59], s92 offen offset:0 sc1
    buffer_load_dwordx4 v[132:135], v10, s[56:59], s92 offen offset:1024 sc1
    s_add_u32 s91, s91, 2048
    s_and_b32 s91, s91, 0x3fff
    s_add_u32 s92, s91, s71
    buffer_load_dwordx4 v[136:139], v10, s[56:59], s92 offen offset:0 sc1
    buffer_load_dwordx4 v[140:143], v10, s[56:59], s92 offen offset:1024 sc1
    s_add_u32 s91, s91, 2048
    s_and_b32 s91, s91, 0x3fff
    s_add_u32 s92, s91, s71
    buffer_load_dwordx4 v[144:147], v10, s[56:59], s92 offen offset:0 sc1
    buffer_load_dwordx4 v[148:151], v10, s[56:59], s92 offen offset:1024 sc1
    s_add_u32 s91, s91, 2048
    s_and_b32 s91, s91, 0x3fff
    s_add_u32 s92, s91, s71
    buffer_load_dwordx4 v[152:155], v10, s[56:59], s92 offen offset:0 sc1
    buffer_load_dwordx4 v[156:159], v10, s[56:59], s92 offen offset:1024 sc1
    s_waitcnt vmcnt(8)
CK_12:
    v_max3_u32 v1, v120, v121, v122
HOP36:
    s_cbranch_execz HOP_RET
    v_max3_u32 v1, v1, v123, v124
    v_max3_u32 v1, v1, v125, v126
    v_max_u32 v1, v1, v127
    v_cmp_eq_u32 vcc, -1, v1
    s_nop 0
    s_cbranch_vccz CK_12_ok
    s_cmp_eq_u32 s78, 0
    s_cbranch_scc1 CK_12_ok
    s_sub_u32 s78, s78, 1
    s_sleep 1
    s_add_u32 s4, s64, 0
    s_and_b32 s4, s4, 7
    s_lshl_b32 s4, s4, 11
    s_add_u32 s4, s4, s71
    buffer_load_dwordx4 v[120:123], v10, s[56:59], s4 offen offset:0 sc1
    buffer_load_dwordx4 v[124:127], v10, s[56:59], s4 offen offset:1024 sc1
    s_waitcnt vmcnt(0)
    s_branch CK_12
CK_12_ok:
    s_add_u32 s91, s91, 2048
    s_and_b32 s91, s91, 0x3fff
    s_add_u32 s92, s91, s71
    buffer_load_dwordx4 v[160:163], v10, s[56:59], s92 offen offset:0 sc1
    ds_write_b128 v22, v[120:123] offset:0
    v_mfma_f32_16x16x32_bf16 v[248:251], v[24:27], v[120:123], 0
    v_mfma_f32_16x16x32_bf16 v[252:255], v[120:123], v[120:123], 0
    buffer_load_dwordx4 v[164:167], v10, s[56:59], s92 offen offset:1024 sc1
    ds_write_b128 v22, v[124:127] offset:1024
    v_mfma_f32_16x16x32_bf16 v[248:251], v[24:27], v[124:127], v[248:251]
    v_mfma_f32_16x16x32_bf16 v[252:255], v[124:127], v[124:127], v[252:255]
    s_add_u32 s91, s91, 2048
    s_and_b32 s91, s91, 0x3fff
    s_add_u32 s92, s91, s71
    buffer_load_dwordx4 v[168:171], v10, s[56:59], s92 offen offset:0 sc1
    s_waitcnt vmcnt(9)
CK_13:
    v_max3_u32 v1, v128, v129, v130
    v_max3_u32 v1, v1, v131, v132
    v_max3_u32 v1, v1, v133, v134
    v_max_u32 v1, v1, v135
    v_cmp_eq_u32 vcc, -1, v1
    s_nop 0
    s_cbranch_vccz CK_13_ok
HOP37:
    s_cbranch_execz HOP_RET
    s_cmp_eq_u32 s78, 0
    s_cbranch_scc1 CK_13_ok
    s_sub_u32 s78, s78, 1
    s_sleep 1
    s_add_u32 s4, s64, 1
    s_and_b32 s4, s4, 7
    s_lshl_b32 s4, s4, 11
    s_add_u32 s4, s4, s71
    buffer_load_dwordx4 v[128:131], v10, s[56:59], s4 offen offset:0 sc1
    buffer_load_dwordx4 v[132:135], v10, s[56:59], s4 offen offset:1024 sc1
    s_waitcnt vmcnt(0)
    s_branch CK_13
CK_13_ok:
    buffer_load_dwordx4 v[172:175], v10, s[56:59], s92 offen offset:1024 sc1
    ds_write_b128 v22, v[128:131] offset:2048
    v_mfma_f32_16x16x32_bf16 v[248:251], v[24:27], v[128:131], v[248:251]
    v_mfma_f32_16x16x32_bf16 v[252:255], v[128:131], v[128:131], v[252:255]
    s_add_u32 s91, s91, 2048
    s_and_b32 s91, s91, 0x3fff
    s_add_u32 s92, s91, s71
    buffer_load_dwordx4 v[176:179], v10, s[56:59], s92 offen offset:0 sc1
    ds_write_b128 v22, v[132:135] offset:3072
    v_mfma_f32_16x16x32_bf16 v[248:251], v[24:27], v[132:135], v[248:251]
    v_mfma_f32_16x16x32_bf16 v[252:255], v[132:135], v[132:135], v[252:255]
    buffer_load_dwordx4 v[180:183], v10, s[56:59], s92 offen offset:1024 sc1
    s_add_u32 m0, s74, 69632
    s_add_u32 s79, s79, 28672
    buffer_load_dwordx4 v11, s[44:47], s79 offen lds
    buffer_load_dwordx4 v12, s[44:47], s79 offen offset:1024 lds
    s_add_u32 m0, s74, 71680
    s_add_u32 s79, s79, 86016
    s_cmp_eq_u32 s79, 1835008
    s_cselect_b32 s79, 0, s79
    buffer_load_dwordx4 v11, s[44:47], s79 offen lds
    buffer_load_dwordx4 v12, s[44:47], s79 offen offset:1024 lds
    s_waitcnt lgkmcnt(0)
    s_barrier
    ds_read_b128 v[96:99], v17 offset:0
    ds_read_b128 v[100:103], v17 offset:32768
HOP38:
    s_cbranch_execz HOP_RET
    ds_read_b128 v[104:107], v17 offset:512
    ds_read_b128 v[108:111], v17 offset:33280
    ds_read_b128 v[112:115], v17 offset:1024
    ds_read_b128 v[116:119], v17 offset:33792
    s_waitcnt lgkmcnt(4)
    v_mfma_f32_32x32x16_bf16 v[32:47], a[0:3], v[96:99], 0
    s_waitcnt vmcnt(14)
CK_14:
    v_max3_u32 v1, v136, v137, v138
    v_max3_u32 v1, v1, v139, v140
    v_max3_u32 v1, v1, v141, v142
    v_max_u32 v1, v1, v143
    v_cmp_eq_u32 vcc, -1, v1
    s_nop 0
    s_cbranch_vccz CK_14_ok
    s_cmp_eq_u32 s78, 0
    s_cbranch_scc1 CK_14_ok
    s_sub_u32 s78, s78, 1
    s_sleep 1
    s_add_u32 s4, s64, 2
    s_and_b32 s4, s4, 7
    s_lshl_b32 s4, s4, 11
    s_add_u32 s4, s4, s71
    buffer_load_dwordx4 v[136:139], v10, s[56:59], s4 offen offset:0 sc1
    buffer_load_dwordx4 v[140:143], v10, s[56:59], s4 offen offset:1024 sc1
    s_waitcnt vmcnt(0)
    s_branch CK_14
CK_14_ok:
    s_add_u32 m0, s74, 73728
    s_add_u32 s79, s79, 28672
    buffer_load_dwordx4 v11, s[44:47], s79 offen lds
    v_mfma_f32_32x32x16_bf16 v[48:63], a[0:3], v[100:103], 0
    ds_write_b128 v22, v[136:139] offset:4096
    v_mfma_f32_16x16x32_bf16 v[248:251], v[24:27], v[136:139], v[248:251]
    v_mfma_f32_16x16x32_bf16 v[252:255], v[136:139], v[136:139], v[252:255]
    buffer_load_dwordx4 v12, s[44:47], s79 offen offset:1024 lds
    v_mfma_f32_32x32x16_bf16 v[64:79], a[4:7], v[96:99], 0
    ds_write_b128 v22, v[140:143] offset:5120
    v_mfma_f32_16x16x32_bf16 v[248:251], v[24:27], v[140:143], v[248:251]
    v_mfma_f32_16x16x32_bf16 v[252:255], v[140:143], v[140:143], v[252:255]
    v_mfma_f32_32x32x16_bf16 v[80:95], a[4:7], v[100:103], 0
HOP39:
    s_cbranch_execz HOP_RET
    s_waitcnt vmcnt(14)
CK_15:
    v_max3_u32 v1, v144, v145, v146
    v_max3_u32 v1, v1, v147, v148
    v_max3_u32 v1, v1, v149, v150
    v_max_u32 v1, v1, v151
    v_cmp_eq_u32 vcc, -1, v1
    s_nop 0
    s_cbranch_vccz CK_15_ok
    s_cmp_eq_u32 s78, 0
    s_cbranch_scc1 CK_15_ok
    s_sub_u32 s78, s78, 1
    s_sleep 1
    s_add_u32 s4, s64, 3
    s_and_b32 s4, s4, 7
    s_lshl_b32 s4, s4, 11
    s_add_u32 s4, s4, s71
    buffer_load_dwordx4 v[144:147], v10, s[56:59], s4 offen offset:0 sc1
    buffer_load_dwordx4 v[148:151], v10, s[56:59], s4 offen offset:1024 sc1
    s_waitcnt vmcnt(0)
    s_branch CK_15
CK_15_ok:
    ds_read_b128 v[96:99], v17 offset:1536
    ds_read_b128 v[100:103], v17 offset:34304
    s_waitcnt lgkmcnt(6)
    v_mfma_f32_32x32x16_bf16 v[32:47], a[8:11], v[104:107], v[32:47]
    ds_write_b128 v22, v[144:147] offset:6144
    v_mfma_f32_16x16x32_bf16 v[248:251], v[24:27], v[144:147], v[248:251]
    v_mfma_f32_16x16x32_bf16 v[252:255], v[144:147], v[144:147], v[252:255]
    s_add_u32 m0, s74, 75776
    s_add_u32 s79, s79, 86016
    buffer_load_dwordx4 v11, s[44:47], s79 offen lds
    v_mfma_f32_32x32x16_bf16 v[48:63], a[8:11], v[108:111], v[48:63]
    ds_write_b128 v22, v[148:151] offset:7168
    v_mfma_f32_16x16x32_bf16 v[248:251], v[24:27], v[148:151], v[248:251]
    v_mfma_f32_16x16x32_bf16 v[252:255], v[148:151], v[148:151], v[252:255]
    buffer_load_dwordx4 v12, s[44:47], s79 offen offset:1024 lds
    v_mfma_f32_32x32x16_bf16 v[64:79], a[12:15], v[104:107], v[64:79]
    s_waitcnt vmcnt(14)
CK_16:
    v_max3_u32 v1, v152, v153, v154
    v_max3_u32 v1, v1, v155, v156
HOP40:
    s_cbranch_execz HOP_RET
    v_max3_u32 v1, v1, v157, v158
    v_max_u32 v1, v1, v159
    v_cmp_eq_u32 vcc, -1, v1
    s_nop 0
    s_cbranch_vccz CK_16_ok
    s_cmp_eq_u32 s78, 0
    s_cbranch_scc1 CK_16_ok
    s_sub_u32 s78, s78, 1
    s_sleep 1
    s_add_u32 s4, s64, 4
    s_and_b32 s4, s4, 7
    s_lshl_b32 s4, s4, 11
    s_add_u32 s4, s4, s71
    buffer_load_dwordx4 v[152:155], v10, s[56:59], s4 offen offset:0 sc1
    buffer_load_dwordx4 v[156:159], v10, s[56:59], s4 offen offset:1024 sc1
    s_waitcnt vmcnt(0)
    s_branch CK_16
CK_16_ok:
    v_mfma_f32_32x32x16_bf16 v[80:95], a[12:15], v[108:111], v[80:95]
    ds_write_b128 v22, v[152:155] offset:8192
    v_mfma_f32_16x16x32_bf16 v[248:251], v[24:27], v[152:155], v[248:251]
    v_mfma_f32_16x16x32_bf16 v[252:255], v[152:155], v[152:155], v[252:255]
    ds_read_b128 v[104:107], v17 offset:2048
    ds_read_b128 v[108:111], v17 offset:34816
    s_waitcnt lgkmcnt(9)
    v_mfma_f32_32x32x16_bf16 v[32:47], a[16:19], v[112:115], v[32:47]
    ds_write_b128 v22, v[156:159] offset:9216
    v_mfma_f32_16x16x32_bf16 v[248:251], v[24:27], v[156:159], v[248:251]
    v_mfma_f32_16x16x32_bf16 v[252:255], v[156:159], v[156:159], v[252:255]
    s_add_u32 m0, s74, 77824
    s_add_u32 s79, s79, 28672
    buffer_load_dwordx4 v11, s[44:47], s79 offen lds
    s_mov_b32 s81, s75
    s_add_u32 s70, s74, 0
    s_sub_u32 s81, s81, s70
    v_add_u32 v15, s81, v15
    v_add_u32 v16, s81, v16
    ds_read_b64_tr_b16 a[64:65], v15 offset:0
    ds_read_b64_tr_b16 a[66:67], v15 offset:1024
    v_mfma_f32_32x32x16_bf16 v[48:63], a[16:19], v[116:119], v[48:63]
    s_waitcnt vmcnt(13)
CK_17:
    v_max3_u32 v1, v160, v161, v162
HOP41:
    s_cbranch_execz HOP_RET
    v_max3_u32 v1, v1, v163, v164
    v_max3_u32 v1, v1, v165, v166
    v_max_u32 v1, v1, v167
    v_cmp_eq_u32 vcc, -1, v1
    s_nop 0
    s_cbranch_vccz CK_17_ok
    s_cmp_eq_u32 s78, 0
    s_cbranch_scc1 CK_17_ok
    s_sub_u32 s78, s78, 1
    s_sleep 1
    s_add_u32 s4, s64, 5
    s_and_b32 s4, s4, 7
    s_lshl_b32 s4, s4, 11
    s_add_u32 s4, s4, s71
    buffer_load_dwordx4 v[160:163], v10, s[56:59], s4 offen offset:0 sc1
    buffer_load_dwordx4 v[164:167], v10, s[56:59], s4 offen offset:1024 sc1
    s_waitcnt vmcnt(0)
    s_branch CK_17
CK_17_ok:
    buffer_load_dwordx4 v12, s[44:47], s79 offen offset:1024 lds
    ds_read_b64_tr_b16 a[68:69], v16 offset:0
    ds_read_b64_tr_b16 a[70:71], v16 offset:1024
    v_mfma_f32_32x32x16_bf16 v[64:79], a[20:23], v[112:115], v[64:79]
    ds_write_b128 v22, v[160:163] offset:10240
    v_mfma_f32_16x16x32_bf16 v[248:251], v[24:27], v[160:163], v[248:251]
    v_mfma_f32_16x16x32_bf16 v[252:255], v[160:163], v[160:163], v[252:255]
    s_add_u32 m0, s74, 79872
    s_add_u32 s79, s79, 86016
    s_cmp_eq_u32 s79, 1835008
    s_cselect_b32 s79, 0, s79
    buffer_load_dwordx4 v11, s[44:47], s79 offen lds
    s_add_u32 s81, s74, 65536
    s_mov_b32 s70, s75
    s_sub_u32 s81, s81, s70
    v_add_u32 v15, s81, v15
    v_add_u32 v16, s81, v16
    ds_read_b64_tr_b16 a[72:73], v15 offset:0
    ds_read_b64_tr_b16 a[74:75], v15 offset:1024
    v_mfma_f32_32x32x16_bf16 v[80:95], a[20:23], v[116:119], v[80:95]
    ds_write_b128 v22, v[164:167] offset:11264
    v_mfma_f32_16x16x32_bf16 v[248:251], v[24:27], v[164:167], v[248:251]
HOP42:
    s_cbranch_execz HOP_RET
    v_mfma_f32_16x16x32_bf16 v[252:255], v[164:167], v[164:167], v[252:255]
    buffer_load_dwordx4 v12, s[44:47], s79 offen offset:1024 lds
    ds_read_b64_tr_b16 a[76:77], v16 offset:0
    ds_read_b64_tr_b16 a[78:79], v16 offset:1024
    ds_read_b128 v[112:115], v17 offset:2560
    ds_read_b128 v[116:119], v17 offset:35328
    s_waitcnt lgkmcnt(15)
    v_mfma_f32_32x32x16_bf16 v[32:47], a[24:27], v[96:99], v[32:47]
    s_waitcnt vmcnt(14)
CK_18:
    v_max3_u32 v1, v168, v169, v170
    v_max3_u32 v1, v1, v171, v172
    v_max3_u32 v1, v1, v173, v174
    v_max_u32 v1, v1, v175
    v_cmp_eq_u32 vcc, -1, v1
    s_nop 0
    s_cbranch_vccz CK_18_ok
    s_cmp_eq_u32 s78, 0
    s_cbranch_scc1 CK_18_ok
    s_sub_u32 s78, s78, 1
    s_sleep 1
    s_add_u32 s4, s64, 6
    s_and_b32 s4, s4, 7
    s_lshl_b32 s4, s4, 11
    s_add_u32 s4, s4, s71
    buffer_load_dwordx4 v[168:171], v10, s[56:59], s4 offen offset:0 sc1
    buffer_load_dwordx4 v[172:175], v10, s[56:59], s4 offen offset:1024 sc1
    s_waitcnt vmcnt(0)
    s_branch CK_18
CK_18_ok:
    s_add_u32 m0, s75, 2048
    s_add_u32 s79, s79, 28672
    buffer_load_dwordx4 v11, s[44:47], s79 offen lds
    v_mfma_f32_32x32x16_bf16 v[48:63], a[24:27], v[100:103], v[48:63]
    ds_write_b128 v22, v[168:171] offset:12288
    v_mfma_f32_16x16x32_bf16 v[248:251], v[24:27], v[168:171], v[248:251]
    v_mfma_f32_16x16x32_bf16 v[252:255], v[168:171], v[168:171], v[252:255]
    ds_read_b64_tr_b16 a[80:81], v15 offset:2048
    ds_read_b64_tr_b16 a[82:83], v15 offset:3072
    v_mfma_f32_32x32x16_bf16 v[64:79], a[28:31], v[96:99], v[64:79]
    ds_write_b128 v22, v[172:175] offset:13312
HOP43:
    s_cbranch_execz HOP_RET
    v_mfma_f32_16x16x32_bf16 v[248:251], v[24:27], v[172:175], v[248:251]
    v_mfma_f32_16x16x32_bf16 v[252:255], v[172:175], v[172:175], v[252:255]
    buffer_load_dwordx4 v12, s[44:47], s79 offen offset:1024 lds
    v_mfma_f32_32x32x16_bf16 v[80:95], a[28:31], v[100:103], v[80:95]
    s_waitcnt vmcnt(14)
CK_19:
    v_max3_u32 v1, v176, v177, v178
    v_max3_u32 v1, v1, v179, v180
    v_max3_u32 v1, v1, v181, v182
    v_max_u32 v1, v1, v183
    v_cmp_eq_u32 vcc, -1, v1
    s_nop 0
    s_cbranch_vccz CK_19_ok
    s_cmp_eq_u32 s78, 0
    s_cbranch_scc1 CK_19_ok
    s_sub_u32 s78, s78, 1
    s_sleep 1
    s_add_u32 s4, s64, 7
    s_and_b32 s4, s4, 7
    s_lshl_b32 s4, s4, 11
    s_add_u32 s4, s4, s71
    buffer_load_dwordx4 v[176:179], v10, s[56:59], s4 offen offset:0 sc1
    buffer_load_dwordx4 v[180:183], v10, s[56:59], s4 offen offset:1024 sc1
    s_waitcnt vmcnt(0)
    s_branch CK_19
CK_19_ok:
    ds_read_b64_tr_b16 a[84:85], v16 offset:2048
    ds_read_b64_tr_b16 a[86:87], v16 offset:3072
    ds_read_b128 v[96:99], v17 offset:3072
    ds_read_b128 v[100:103], v17 offset:35840
    s_waitcnt lgkmcnt(15)
    v_mfma_f32_32x32x16_bf16 v[32:47], a[32:35], v[104:107], v[32:47]
    ds_write_b128 v22, v[176:179] offset:14336
    v_mfma_f32_16x16x32_bf16 v[248:251], v[24:27], v[176:179], v[248:251]
    v_mfma_f32_16x16x32_bf16 v[252:255], v[176:179], v[176:179], v[252:255]
    s_add_u32 m0, s75, 4096
    s_add_u32 s79, s79, 86016
    buffer_load_dwordx4 v11, s[44:47], s79 offen lds
    s_waitcnt vmcnt(13)
    ds_read_b64_tr_b16 a[88:89], v15 offset:4096
    ds_read_b64_tr_b16 a[90:91], v15 offset:5120
HOP44:
    s_cbranch_execz HOP_RET
    v_mfma_f32_32x32x16_bf16 v[48:63], a[32:35], v[108:111], v[48:63]
    ds_write_b128 v22, v[180:183] offset:15360
    v_mfma_f32_16x16x32_bf16 v[248:251], v[24:27], v[180:183], v[248:251]
    v_mfma_f32_16x16x32_bf16 v[252:255], v[180:183], v[180:183], v[252:255]
    buffer_load_dwordx4 v12, s[44:47], s79 offen offset:1024 lds
    ds_read_b64_tr_b16 a[92:93], v16 offset:4096
    ds_read_b64_tr_b16 a[94:95], v16 offset:5120
    v_mfma_f32_32x32x16_bf16 v[64:79], a[36:39], v[104:107], v[64:79]
    s_add_u32 m0, s75, 0
    s_add_u32 s79, s79, 28672
    buffer_load_dwordx4 v11, s[44:47], s79 offen lds
    s_waitcnt vmcnt(13)
    ds_read_b64_tr_b16 a[96:97], v15 offset:6144
    ds_read_b64_tr_b16 a[98:99], v15 offset:7168
    v_mfma_f32_32x32x16_bf16 v[80:95], a[36:39], v[108:111], v[80:95]
    buffer_load_dwordx4 v12, s[44:47], s79 offen offset:1024 lds
    ds_read_b64_tr_b16 a[100:101], v16 offset:6144
    ds_read_b64_tr_b16 a[102:103], v16 offset:7168
    ds_read_b128 v[104:107], v17 offset:3584
    ds_read_b128 v[108:111], v17 offset:36352
    s_waitcnt lgkmcnt(15)
    v_mfma_f32_32x32x16_bf16 v[32:47], a[40:43], v[112:115], v[32:47]
    s_add_u32 m0, s74, 65536
    s_add_u32 s79, s79, 86016
    s_cmp_eq_u32 s79, 1835008
    s_cselect_b32 s79, 0, s79
    buffer_load_dwordx4 v11, s[44:47], s79 offen lds
    v_mfma_f32_32x32x16_bf16 v[48:63], a[40:43], v[116:119], v[48:63]
    s_waitcnt vmcnt(13)
    ds_read_b64_tr_b16 a[104:105], v15 offset:8192
    ds_read_b64_tr_b16 a[106:107], v15 offset:9216
    v_mfma_f32_32x32x16_bf16 v[64:79], a[44:47], v[112:115], v[64:79]
    buffer_load_dwordx4 v12, s[44:47], s79 offen offset:1024 lds
HOP45:
    s_cbranch_execz HOP_RET
    v_mfma_f32_32x32x16_bf16 v[80:95], a[44:47], v[116:119], v[80:95]
    ds_read_b64_tr_b16 a[108:109], v16 offset:8192
    ds_read_b64_tr_b16 a[110:111], v16 offset:9216
    s_waitcnt lgkmcnt(12)
    s_barrier
    ds_read_b128 v[112:115], v17 offset:4096
    ds_read_b128 v[116:119], v17 offset:36864
    v_mfma_f32_32x32x16_bf16 v[32:47], a[48:51], v[96:99], v[32:47]
    s_add_u32 m0, s74, 67584
    s_add_u32 s79, s79, 28672
    buffer_load_dwordx4 v11, s[44:47], s79 offen lds
    s_waitcnt vmcnt(13)
    ds_read_b64_tr_b16 a[112:113], v15 offset:10240
    ds_read_b64_tr_b16 a[114:115], v15 offset:11264
    v_mfma_f32_32x32x16_bf16 v[48:63], a[48:51], v[100:103], v[48:63]
    buffer_load_dwordx4 v12, s[44:47], s79 offen offset:1024 lds
    ds_read_b64_tr_b16 a[116:117], v16 offset:10240
    ds_read_b64_tr_b16 a[118:119], v16 offset:11264
    v_mfma_f32_32x32x16_bf16 v[64:79], a[52:55], v[96:99], v[64:79]
    s_waitcnt lgkmcnt(15)
    s_add_u32 m0, s74, 69632
    s_add_u32 s79, s79, 86016
    buffer_load_dwordx4 v11, s[44:47], s79 offen lds
    s_waitcnt vmcnt(13)
    ds_read_b64_tr_b16 a[120:121], v15 offset:12288
    ds_read_b64_tr_b16 a[122:123], v15 offset:13312
    v_mfma_f32_32x32x16_bf16 v[80:95], a[52:55], v[100:103], v[80:95]
    buffer_load_dwordx4 v12, s[44:47], s79 offen offset:1024 lds
    ds_read_b64_tr_b16 a[124:125], v16 offset:12288
    ds_read_b64_tr_b16 a[126:127], v16 offset:13312
    ds_read_b128 v[96:99], v17 offset:4608
    ds_read_b128 v[100:103], v17 offset:37376
    s_waitcnt lgkmcnt(15)
    v_mfma_f32_32x32x16_bf16 v[32:47], a[56:59], v[104:107], v[32:47]
HOP46:
    s_cbranch_execz HOP_RET
    v_and_b32 v4, 3, v0
    v_lshrrev_b32 v5, 2, v2
    v_lshl_add_u32 v5, v5, 4, v2
    v_lshlrev_b32 v5, 2, v5
    s_add_u32 m0, s74, 71680
    s_add_u32 s79, s79, 28672
    buffer_load_dwordx4 v11, s[44:47], s79 offen lds
    v_mfma_f32_32x32x16_bf16 v[48:63], a[56:59], v[108:111], v[48:63]
    v_cmp_eq_u32 vcc, 1, v4
    s_nop 1
    v_cndmask_b32 v252, v252, v253, vcc
    s_waitcnt vmcnt(13)
    ds_read_b64_tr_b16 a[128:129], v15 offset:14336
    ds_read_b64_tr_b16 a[130:131], v15 offset:15360
    v_mfma_f32_32x32x16_bf16 v[64:79], a[60:63], v[104:107], v[64:79]
    v_cmp_eq_u32 vcc, 2, v4
    s_nop 1
    v_cndmask_b32 v252, v252, v254, vcc
    buffer_load_dwordx4 v12, s[44:47], s79 offen offset:1024 lds
    v_mfma_f32_32x32x16_bf16 v[80:95], a[60:63], v[108:111], v[80:95]
    v_cmp_eq_u32 vcc, 3, v4
    s_nop 1
    v_cndmask_b32 v252, v252, v255, vcc
    ds_read_b64_tr_b16 a[132:133], v16 offset:14336
    ds_read_b64_tr_b16 a[134:135], v16 offset:15360
    ds_read_b128 v[104:107], v17 offset:5120
    ds_read_b128 v[108:111], v17 offset:37888
    s_waitcnt lgkmcnt(15)
    v_mfma_f32_32x32x16_bf16 v[32:47], a[64:67], v[112:115], v[32:47]
    ds_bpermute_b32 v252, v5, v252
    s_lshl_b32 s65, s60, 8
    s_add_u32 s65, s65, 156160
    v_lshlrev_b32 v6, 4, v2
    v_add_u32 v6, s65, v6
    s_add_u32 m0, s74, 73728
    s_add_u32 s79, s79, 86016
    s_cmp_eq_u32 s79, 1835008
    s_cselect_b32 s79, 0, s79
    buffer_load_dwordx4 v11, s[44:47], s79 offen lds
    s_mov_b32 s81, s75
HOP47:
    s_cbranch_execz HOP_RET
    s_add_u32 s70, s74, 65536
    s_sub_u32 s81, s81, s70
    v_add_u32 v15, s81, v15
    v_add_u32 v16, s81, v16
    s_waitcnt vmcnt(13)
    ds_read_b64_tr_b16 a[136:137], v15 offset:2048
    ds_read_b64_tr_b16 a[138:139], v15 offset:3072
    v_mfma_f32_32x32x16_bf16 v[48:63], a[64:67], v[116:119], v[48:63]
    buffer_load_dwordx4 v12, s[44:47], s79 offen offset:1024 lds
    ds_read_b64_tr_b16 a[140:141], v16 offset:2048
    ds_read_b64_tr_b16 a[142:143], v16 offset:3072
    v_mfma_f32_32x32x16_bf16 v[64:79], a[68:71], v[112:115], v[64:79]
    s_waitcnt lgkmcnt(4)
    v_mul_f32 v248, 0x3b000000, v248
    v_mul_f32 v252, 0x3b000000, v252
    v_fma_f32 v252, -v248, v248, v252
    v_max_f32 v252, 0, v252
    v_add_f32 v252, 0x3727c5ac, v252
    v_sub_f32 v144, 0, v248
    v_rsq_f32 v248, v252
    s_nop 0
    v_mul_f32 v147, v252, v248
    v_mul_f32 v145, 0xc0135761, v248
    v_mul_f32 v252, v248, v248
    v_mul_f32 v252, 0x3d372713, v252
    v_mul_f32 v146, v252, v145
    s_add_u32 m0, s74, 75776
    s_add_u32 s79, s79, 28672
    buffer_load_dwordx4 v11, s[44:47], s79 offen lds
    s_waitcnt vmcnt(13)
    ds_read_b64_tr_b16 a[144:145], v15 offset:4096
    ds_read_b64_tr_b16 a[146:147], v15 offset:5120
    v_mfma_f32_32x32x16_bf16 v[80:95], a[68:71], v[116:119], v[80:95]
    ds_write_b128 v6, v[144:147]
    buffer_load_dwordx4 v12, s[44:47], s79 offen offset:1024 lds
    ds_read_b64_tr_b16 a[148:149], v16 offset:4096
    ds_read_b64_tr_b16 a[150:151], v16 offset:5120
HOP48:
    s_cbranch_execz HOP_RET
    v_mfma_f32_16x16x32_bf16 v[184:187], a[64:67], v[28:31], v[184:187]
    v_mfma_f32_16x16x32_bf16 v[188:191], a[68:71], v[28:31], v[188:191]
    ds_read_b128 v[112:115], v17 offset:5632
    ds_read_b128 v[116:119], v17 offset:38400
    v_mfma_f32_32x32x16_bf16 v[32:47], a[72:75], v[96:99], v[32:47]
    s_add_u32 m0, s74, 77824
    s_add_u32 s79, s79, 86016
    buffer_load_dwordx4 v11, s[44:47], s79 offen lds
    v_mfma_f32_32x32x16_bf16 v[48:63], a[72:75], v[100:103], v[48:63]
    s_waitcnt vmcnt(13)
    ds_read_b64_tr_b16 a[152:153], v15 offset:0
    ds_read_b64_tr_b16 a[154:155], v15 offset:1024
    v_mfma_f32_32x32x16_bf16 v[64:79], a[76:79], v[96:99], v[64:79]
    buffer_load_dwordx4 v12, s[44:47], s79 offen offset:1024 lds
    v_mfma_f32_32x32x16_bf16 v[80:95], a[76:79], v[100:103], v[80:95]
    ds_read_b64_tr_b16 a[156:157], v16 offset:0
    ds_read_b64_tr_b16 a[158:159], v16 offset:1024
    v_mfma_f32_16x16x32_bf16 v[184:187], a[72:75], v[28:31], v[184:187]
    v_mfma_f32_16x16x32_bf16 v[188:191], a[76:79], v[28:31], v[188:191]
    ds_read_b128 v[96:99], v17 offset:6144
    ds_read_b128 v[100:103], v17 offset:38912
    v_mfma_f32_32x32x16_bf16 v[32:47], a[80:83], v[104:107], v[32:47]
    s_add_u32 m0, s74, 79872
    s_add_u32 s79, s79, 28672
    buffer_load_dwordx4 v11, s[44:47], s79 offen lds
    s_add_u32 s81, s74, 65536
    s_mov_b32 s70, s75
    s_sub_u32 s81, s81, s70
    v_add_u32 v15, s81, v15
    v_add_u32 v16, s81, v16
    s_waitcnt vmcnt(13)
    ds_read_b64_tr_b16 a[160:161], v15 offset:0
    ds_read_b64_tr_b16 a[162:163], v15 offset:1024
    v_mfma_f32_32x32x16_bf16 v[48:63], a[80:83], v[108:111], v[48:63]
HOP49:
    s_cbranch_execz HOP_RET
    buffer_load_dwordx4 v12, s[44:47], s79 offen offset:1024 lds
    ds_read_b64_tr_b16 a[164:165], v16 offset:0
    ds_read_b64_tr_b16 a[166:167], v16 offset:1024
    v_mfma_f32_32x32x16_bf16 v[64:79], a[84:87], v[104:107], v[64:79]
    s_waitcnt lgkmcnt(15)
    s_add_u32 m0, s75, 2048
    s_add_u32 s79, s79, 86016
    s_cmp_eq_u32 s79, 1835008
    s_cselect_b32 s79, 0, s79
    buffer_load_dwordx4 v11, s[44:47], s79 offen lds
    s_waitcnt vmcnt(13)
    ds_read_b64_tr_b16 a[168:169], v15 offset:2048
    ds_read_b64_tr_b16 a[170:171], v15 offset:3072
    v_mfma_f32_32x32x16_bf16 v[80:95], a[84:87], v[108:111], v[80:95]
    buffer_load_dwordx4 v12, s[44:47], s79 offen offset:1024 lds
    ds_read_b64_tr_b16 a[172:173], v16 offset:2048
    ds_read_b64_tr_b16 a[174:175], v16 offset:3072
    v_mfma_f32_16x16x32_bf16 v[184:187], a[80:83], v[28:31], v[184:187]
    v_mfma_f32_16x16x32_bf16 v[188:191], a[84:87], v[28:31], v[188:191]
    ds_read_b128 v[104:107], v17 offset:6656
    ds_read_b128 v[108:111], v17 offset:39424
    s_waitcnt lgkmcnt(15)
    v_mfma_f32_32x32x16_bf16 v[32:47], a[88:91], v[112:115], v[32:47]
    s_add_u32 m0, s75, 4096
    s_add_u32 s79, s79, 28672
    buffer_load_dwordx4 v11, s[44:47], s79 offen lds
    v_mfma_f32_32x32x16_bf16 v[48:63], a[88:91], v[116:119], v[48:63]
    s_waitcnt vmcnt(13)
    ds_read_b64_tr_b16 a[176:177], v15 offset:4096
    ds_read_b64_tr_b16 a[178:179], v15 offset:5120
    v_mfma_f32_32x32x16_bf16 v[64:79], a[92:95], v[112:115], v[64:79]
    buffer_load_dwordx4 v12, s[44:47], s79 offen offset:1024 lds
    v_mfma_f32_32x32x16_bf16 v[80:95], a[92:95], v[116:119], v[80:95]
HOP50:
    s_cbranch_execz HOP_RET
    ds_read_b64_tr_b16 a[180:181], v16 offset:4096
    ds_read_b64_tr_b16 a[182:183], v16 offset:5120
    v_mfma_f32_16x16x32_bf16 v[184:187], a[88:91], v[28:31], v[184:187]
    v_mfma_f32_16x16x32_bf16 v[188:191], a[92:95], v[28:31], v[188:191]
    ds_read_b128 v[112:115], v17 offset:7168
    ds_read_b128 v[116:119], v17 offset:39936
    s_waitcnt lgkmcnt(15)
    v_mfma_f32_32x32x16_bf16 v[32:47], a[96:99], v[96:99], v[32:47]
    s_add_u32 m0, s75, 0
    s_add_u32 s79, s79, 86016
    buffer_load_dwordx4 v11, s[44:47], s79 offen lds
    s_waitcnt vmcnt(13)
    ds_read_b64_tr_b16 a[184:185], v15 offset:6144
    ds_read_b64_tr_b16 a[186:187], v15 offset:7168
    v_mfma_f32_32x32x16_bf16 v[48:63], a[96:99], v[100:103], v[48:63]
    buffer_load_dwordx4 v12, s[44:47], s79 offen offset:1024 lds
    ds_read_b64_tr_b16 a[188:189], v16 offset:6144
    ds_read_b64_tr_b16 a[190:191], v16 offset:7168
    v_mfma_f32_32x32x16_bf16 v[64:79], a[100:103], v[96:99], v[64:79]
    s_waitcnt lgkmcnt(15)
    s_add_u32 m0, s74, 65536
    s_add_u32 s79, s79, 28672
    buffer_load_dwordx4 v11, s[44:47], s79 offen lds
    s_waitcnt vmcnt(13)
    ds_read_b64_tr_b16 a[192:193], v15 offset:8192
    ds_read_b64_tr_b16 a[194:195], v15 offset:9216
    v_mfma_f32_32x32x16_bf16 v[80:95], a[100:103], v[100:103], v[80:95]
    buffer_load_dwordx4 v12, s[44:47], s79 offen offset:1024 lds
    ds_read_b64_tr_b16 a[196:197], v16 offset:8192
    ds_read_b64_tr_b16 a[198:199], v16 offset:9216
    v_mfma_f32_16x16x32_bf16 v[184:187], a[96:99], v[28:31], v[184:187]
    v_mfma_f32_16x16x32_bf16 v[188:191], a[100:103], v[28:31], v[188:191]
    ds_read_b128 v[96:99], v17 offset:7680
HOP51:
    s_cbranch_execz HOP_RET
    ds_read_b128 v[100:103], v17 offset:40448
    s_waitcnt lgkmcnt(15)
    v_mfma_f32_32x32x16_bf16 v[32:47], a[104:107], v[104:107], v[32:47]
    s_add_u32 m0, s74, 67584
    s_bfe_u32 s80, s6, 0x40000
    s_lshl_b32 s80, s80, 15
    buffer_load_dwordx4 v13, s[48:51], s80 offen lds
    v_mfma_f32_32x32x16_bf16 v[48:63], a[104:107], v[108:111], v[48:63]
    s_waitcnt vmcnt(13)
    ds_read_b64_tr_b16 a[200:201], v15 offset:10240
    ds_read_b64_tr_b16 a[202:203], v15 offset:11264
    v_mfma_f32_32x32x16_bf16 v[64:79], a[108:111], v[104:107], v[64:79]
    buffer_load_dwordx4 v14, s[48:51], s80 offen offset:1024 lds
    v_mfma_f32_32x32x16_bf16 v[80:95], a[108:111], v[108:111], v[80:95]
    ds_read_b64_tr_b16 a[204:205], v16 offset:10240
    ds_read_b64_tr_b16 a[206:207], v16 offset:11264
    v_mfma_f32_16x16x32_bf16 v[184:187], a[104:107], v[28:31], v[184:187]
    v_mfma_f32_16x16x32_bf16 v[188:191], a[108:111], v[28:31], v[188:191]
    ds_read_b128 v[104:107], v17 offset:8192
    ds_read_b128 v[108:111], v17 offset:40960
    s_waitcnt lgkmcnt(15)
    v_mfma_f32_32x32x16_bf16 v[32:47], a[112:115], v[112:115], v[32:47]
    s_add_u32 m0, s74, 69632
    s_add_u32 s80, s80, 16384
    buffer_load_dwordx4 v13, s[48:51], s80 offen lds
    s_waitcnt vmcnt(13)
    ds_read_b64_tr_b16 a[208:209], v15 offset:12288
    ds_read_b64_tr_b16 a[210:211], v15 offset:13312
    v_mfma_f32_32x32x16_bf16 v[48:63], a[112:115], v[116:119], v[48:63]
    buffer_load_dwordx4 v14, s[48:51], s80 offen offset:1024 lds
    ds_read_b64_tr_b16 a[212:213], v16 offset:12288
    ds_read_b64_tr_b16 a[214:215], v16 offset:13312
    v_mfma_f32_32x32x16_bf16 v[64:79], a[116:119], v[112:115], v[64:79]
HOP52:
    s_cbranch_execz HOP_RET
    s_waitcnt lgkmcnt(15)
    s_add_u32 m0, s74, 71680
    s_bfe_u32 s80, s6, 0x40004
    s_lshl_b32 s80, s80, 15
    buffer_load_dwordx4 v13, s[48:51], s80 offen lds
    s_waitcnt vmcnt(13)
    ds_read_b64_tr_b16 a[216:217], v15 offset:14336
    ds_read_b64_tr_b16 a[218:219], v15 offset:15360
    v_mfma_f32_32x32x16_bf16 v[80:95], a[116:119], v[116:119], v[80:95]
    buffer_load_dwordx4 v14, s[48:51], s80 offen offset:1024 lds
    ds_read_b64_tr_b16 a[220:221], v16 offset:14336
    ds_read_b64_tr_b16 a[222:223], v16 offset:15360
    v_mfma_f32_16x16x32_bf16 v[184:187], a[112:115], v[28:31], v[184:187]
    v_mfma_f32_16x16x32_bf16 v[188:191], a[116:119], v[28:31], v[188:191]
    ds_read_b128 v[112:115], v17 offset:8704
    ds_read_b128 v[116:119], v17 offset:41472
    s_waitcnt lgkmcnt(15)
    v_mfma_f32_32x32x16_bf16 v[32:47], a[120:123], v[96:99], v[32:47]
    s_add_u32 m0, s74, 73728
    s_add_u32 s80, s80, 16384
    buffer_load_dwordx4 v13, s[48:51], s80 offen lds
    v_mfma_f32_32x32x16_bf16 v[48:63], a[120:123], v[100:103], v[48:63]
    s_mov_b32 s81, s75
    s_add_u32 s70, s74, 65536
    s_sub_u32 s81, s81, s70
    v_add_u32 v15, s81, v15
    v_add_u32 v16, s81, v16
    s_waitcnt vmcnt(13)
    ds_read_b64_tr_b16 a[224:225], v15 offset:2048
    ds_read_b64_tr_b16 a[226:227], v15 offset:3072
    v_mfma_f32_32x32x16_bf16 v[64:79], a[124:127], v[96:99], v[64:79]
    buffer_load_dwordx4 v14, s[48:51], s80 offen offset:1024 lds
    v_mfma_f32_32x32x16_bf16 v[80:95], a[124:127], v[100:103], v[80:95]
    ds_read_b64_tr_b16 a[228:229], v16 offset:2048
    ds_read_b64_tr_b16 a[230:231], v16 offset:3072
HOP53:
    s_cbranch_execz HOP_RET
    v_mfma_f32_16x16x32_bf16 v[184:187], a[120:123], v[28:31], v[184:187]
    v_mfma_f32_16x16x32_bf16 v[188:191], a[124:127], v[28:31], v[188:191]
    ds_read_b128 v[96:99], v17 offset:9216
    ds_read_b128 v[100:103], v17 offset:41984
    s_waitcnt lgkmcnt(15)
    v_mfma_f32_32x32x16_bf16 v[32:47], a[128:131], v[104:107], v[32:47]
    s_add_u32 m0, s74, 75776
    s_bfe_u32 s80, s8, 0x40000
    s_lshl_b32 s80, s80, 15
    buffer_load_dwordx4 v13, s[48:51], s80 offen lds
    s_waitcnt vmcnt(13)
    ds_read_b64_tr_b16 a[232:233], v15 offset:4096
    ds_read_b64_tr_b16 a[234:235], v15 offset:5120
    v_mfma_f32_32x32x16_bf16 v[48:63], a[128:131], v[108:111], v[48:63]
    buffer_load_dwordx4 v14, s[48:51], s80 offen offset:1024 lds
    ds_read_b64_tr_b16 a[236:237], v16 offset:4096
    ds_read_b64_tr_b16 a[238:239], v16 offset:5120
    v_mfma_f32_32x32x16_bf16 v[64:79], a[132:135], v[104:107], v[64:79]
    s_waitcnt lgkmcnt(15)
    s_add_u32 m0, s74, 77824
    s_add_u32 s80, s80, 16384
    buffer_load_dwordx4 v13, s[48:51], s80 offen lds
    s_waitcnt vmcnt(13)
    ds_read_b64_tr_b16 a[240:241], v15 offset:0
    ds_read_b64_tr_b16 a[242:243], v15 offset:1024
    v_mfma_f32_32x32x16_bf16 v[80:95], a[132:135], v[108:111], v[80:95]
    buffer_load_dwordx4 v14, s[48:51], s80 offen offset:1024 lds
    ds_read_b64_tr_b16 a[244:245], v16 offset:0
    ds_read_b64_tr_b16 a[246:247], v16 offset:1024
    v_mfma_f32_16x16x32_bf16 v[184:187], a[128:131], v[28:31], v[184:187]
    v_mfma_f32_16x16x32_bf16 v[188:191], a[132:135], v[28:31], v[188:191]
    ds_read_b128 v[104:107], v17 offset:9728
    ds_read_b128 v[108:111], v17 offset:42496
HOP54:
    s_cbranch_execz HOP_RET
    s_waitcnt lgkmcnt(15)
    v_mfma_f32_32x32x16_bf16 v[32:47], a[136:139], v[112:115], v[32:47]
    s_add_u32 m0, s74, 79872
    s_bfe_u32 s80, s8, 0x40004
    s_lshl_b32 s80, s80, 15
    buffer_load_dwordx4 v13, s[48:51], s80 offen lds
    v_mfma_f32_32x32x16_bf16 v[48:63], a[136:139], v[116:119], v[48:63]
    s_add_u32 s81, s74, 65536
    s_mov_b32 s70, s75
    s_sub_u32 s81, s81, s70
    v_add_u32 v15, s81, v15
    v_add_u32 v16, s81, v16
    s_waitcnt vmcnt(13)
    ds_read_b64_tr_b16 a[248:249], v15 offset:0
    ds_read_b64_tr_b16 a[250:251], v15 offset:1024
    v_mfma_f32_32x32x16_bf16 v[64:79], a[140:143], v[112:115], v[64:79]
    buffer_load_dwordx4 v14, s[48:51], s80 offen offset:1024 lds
    v_mfma_f32_32x32x16_bf16 v[80:95], a[140:143], v[116:119], v[80:95]
    ds_read_b64_tr_b16 a[252:253], v16 offset:0
    ds_read_b64_tr_b16 a[254:255], v16 offset:1024
    v_mfma_f32_16x16x32_bf16 v[184:187], a[136:139], v[28:31], v[184:187]
    v_mfma_f32_16x16x32_bf16 v[188:191], a[140:143], v[28:31], v[188:191]
    ds_read_b128 v[112:115], v17 offset:10240
    ds_read_b128 v[116:119], v17 offset:43008
    s_waitcnt lgkmcnt(15)
    v_mfma_f32_32x32x16_bf16 v[32:47], a[144:147], v[96:99], v[32:47]
    v_mfma_f32_32x32x16_bf16 v[48:63], a[144:147], v[100:103], v[48:63]
    v_mfma_f32_32x32x16_bf16 v[64:79], a[148:151], v[96:99], v[64:79]
    v_mfma_f32_32x32x16_bf16 v[80:95], a[148:151], v[100:103], v[80:95]
    v_mfma_f32_16x16x32_bf16 v[184:187], a[144:147], v[28:31], v[184:187]
    v_mfma_f32_16x16x32_bf16 v[188:191], a[148:151], v[28:31], v[188:191]
    ds_read_b128 v[96:99], v17 offset:10752
    ds_read_b128 v[100:103], v17 offset:43520
    s_waitcnt lgkmcnt(8)
    v_mfma_f32_32x32x16_bf16 v[32:47], a[152:155], v[104:107], v[32:47]
HOP55:
    s_cbranch_execz HOP_RET
    s_add_u32 m0, s75, 2048
    s_add_u32 s80, s80, 16384
    buffer_load_dwordx4 v13, s[48:51], s80 offen lds
    v_mfma_f32_32x32x16_bf16 v[48:63], a[152:155], v[108:111], v[48:63]
    s_waitcnt vmcnt(13)
    ds_read_b64_tr_b16 v[192:193], v15 offset:2048
    ds_read_b64_tr_b16 v[194:195], v15 offset:3072
    v_mfma_f32_32x32x16_bf16 v[64:79], a[156:159], v[104:107], v[64:79]
    buffer_load_dwordx4 v14, s[48:51], s80 offen offset:1024 lds
    v_mfma_f32_32x32x16_bf16 v[80:95], a[156:159], v[108:111], v[80:95]
    ds_read_b64_tr_b16 v[196:197], v16 offset:2048
    ds_read_b64_tr_b16 v[198:199], v16 offset:3072
    v_mfma_f32_16x16x32_bf16 v[184:187], a[152:155], v[28:31], v[184:187]
    v_mfma_f32_16x16x32_bf16 v[188:191], a[156:159], v[28:31], v[188:191]
    ds_read_b128 v[104:107], v17 offset:11264
    ds_read_b128 v[108:111], v17 offset:44032
    s_waitcnt lgkmcnt(8)
    v_mfma_f32_32x32x16_bf16 v[32:47], a[160:163], v[112:115], v[32:47]
    v_mfma_f32_32x32x16_bf16 v[48:63], a[160:163], v[116:119], v[48:63]
    v_mfma_f32_32x32x16_bf16 v[64:79], a[164:167], v[112:115], v[64:79]
    v_mfma_f32_32x32x16_bf16 v[80:95], a[164:167], v[116:119], v[80:95]
    v_mfma_f32_16x16x32_bf16 v[184:187], a[160:163], v[28:31], v[184:187]
    v_mfma_f32_16x16x32_bf16 v[188:191], a[164:167], v[28:31], v[188:191]
    ds_read_b128 v[112:115], v17 offset:11776
    ds_read_b128 v[116:119], v17 offset:44544
    s_waitcnt lgkmcnt(8)
    v_mfma_f32_32x32x16_bf16 v[32:47], a[168:171], v[96:99], v[32:47]
    s_add_u32 m0, s75, 4096
    s_bfe_u32 s80, s6, 0x40008
    s_lshl_b32 s80, s80, 15
    buffer_load_dwordx4 v13, s[48:51], s80 offen lds
    v_mfma_f32_32x32x16_bf16 v[48:63], a[168:171], v[100:103], v[48:63]
    s_waitcnt vmcnt(13)
HOP56:
    s_cbranch_execz HOP_RET
    ds_read_b64_tr_b16 v[200:201], v15 offset:4096
    ds_read_b64_tr_b16 v[202:203], v15 offset:5120
    v_mfma_f32_32x32x16_bf16 v[64:79], a[172:175], v[96:99], v[64:79]
    buffer_load_dwordx4 v14, s[48:51], s80 offen offset:1024 lds
    v_mfma_f32_32x32x16_bf16 v[80:95], a[172:175], v[100:103], v[80:95]
    ds_read_b64_tr_b16 v[204:205], v16 offset:4096
    ds_read_b64_tr_b16 v[206:207], v16 offset:5120
    v_mfma_f32_16x16x32_bf16 v[184:187], a[168:171], v[28:31], v[184:187]
    v_mfma_f32_16x16x32_bf16 v[188:191], a[172:175], v[28:31], v[188:191]
    ds_read_b128 v[96:99], v17 offset:12288
    ds_read_b128 v[100:103], v17 offset:45056
    s_waitcnt lgkmcnt(8)
    v_mfma_f32_32x32x16_bf16 v[32:47], a[176:179], v[104:107], v[32:47]
    v_mfma_f32_32x32x16_bf16 v[48:63], a[176:179], v[108:111], v[48:63]
    v_mfma_f32_32x32x16_bf16 v[64:79], a[180:183], v[104:107], v[64:79]
    v_mfma_f32_32x32x16_bf16 v[80:95], a[180:183], v[108:111], v[80:95]
    v_mfma_f32_16x16x32_bf16 v[184:187], a[176:179], v[28:31], v[184:187]
    v_mfma_f32_16x16x32_bf16 v[188:191], a[180:183], v[28:31], v[188:191]
    ds_read_b128 v[104:107], v17 offset:12800
    ds_read_b128 v[108:111], v17 offset:45568
    s_waitcnt lgkmcnt(8)
    v_mfma_f32_32x32x16_bf16 v[32:47], a[184:187], v[112:115], v[32:47]
    s_add_u32 m0, s75, 0
    s_add_u32 s80, s80, 16384
    buffer_load_dwordx4 v13, s[48:51], s80 offen lds
    v_mfma_f32_32x32x16_bf16 v[48:63], a[184:187], v[116:119], v[48:63]
    s_waitcnt vmcnt(13)
    ds_read_b64_tr_b16 v[208:209], v15 offset:6144
    ds_read_b64_tr_b16 v[210:211], v15 offset:7168
    v_mfma_f32_32x32x16_bf16 v[64:79], a[188:191], v[112:115], v[64:79]
    buffer_load_dwordx4 v14, s[48:51], s80 offen offset:1024 lds
    v_mfma_f32_32x32x16_bf16 v[80:95], a[188:191], v[116:119], v[80:95]
    ds_read_b64_tr_b16 v[212:213], v16 offset:6144
HOP57:
    s_cbranch_execz HOP_RET
    ds_read_b64_tr_b16 v[214:215], v16 offset:7168
    v_mfma_f32_16x16x32_bf16 v[184:187], a[184:187], v[28:31], v[184:187]
    v_mfma_f32_16x16x32_bf16 v[188:191], a[188:191], v[28:31], v[188:191]
    ds_read_b128 v[112:115], v17 offset:13312
    ds_read_b128 v[116:119], v17 offset:46080
    s_waitcnt lgkmcnt(8)
    v_mfma_f32_32x32x16_bf16 v[32:47], a[192:195], v[96:99], v[32:47]
    v_mfma_f32_32x32x16_bf16 v[48:63], a[192:195], v[100:103], v[48:63]
    v_mfma_f32_32x32x16_bf16 v[64:79], a[196:199], v[96:99], v[64:79]
    v_mfma_f32_32x32x16_bf16 v[80:95], a[196:199], v[100:103], v[80:95]
    v_mfma_f32_16x16x32_bf16 v[184:187], a[192:195], v[28:31], v[184:187]
    v_mfma_f32_16x16x32_bf16 v[188:191], a[196:199], v[28:31], v[188:191]
    ds_read_b128 v[96:99], v17 offset:13824
    ds_read_b128 v[100:103], v17 offset:46592
    s_waitcnt lgkmcnt(8)
    v_mfma_f32_32x32x16_bf16 v[32:47], a[200:203], v[104:107], v[32:47]
    s_add_u32 m0, s74, 65536
    s_bfe_u32 s80, s6, 0x4000c
    s_lshl_b32 s80, s80, 15
    buffer_load_dwordx4 v13, s[48:51], s80 offen lds
    v_mfma_f32_32x32x16_bf16 v[48:63], a[200:203], v[108:111], v[48:63]
    s_waitcnt vmcnt(13)
    ds_read_b64_tr_b16 v[216:217], v15 offset:8192
    ds_read_b64_tr_b16 v[218:219], v15 offset:9216
    v_mfma_f32_32x32x16_bf16 v[64:79], a[204:207], v[104:107], v[64:79]
    buffer_load_dwordx4 v14, s[48:51], s80 offen offset:1024 lds
    v_mfma_f32_32x32x16_bf16 v[80:95], a[204:207], v[108:111], v[80:95]
    ds_read_b64_tr_b16 v[220:221], v16 offset:8192
    ds_read_b64_tr_b16 v[222:223], v16 offset:9216
    v_mfma_f32_16x16x32_bf16 v[184:187], a[200:203], v[28:31], v[184:187]
    v_mfma_f32_16x16x32_bf16 v[188:191], a[204:207], v[28:31], v[188:191]
    ds_read_b128 v[104:107], v17 offset:14336
    ds_read_b128 v[108:111], v17 offset:47104
HOP58:
    s_cbranch_execz HOP_RET
    s_waitcnt lgkmcnt(8)
    v_mfma_f32_32x32x16_bf16 v[32:47], a[208:211], v[112:115], v[32:47]
    v_mfma_f32_32x32x16_bf16 v[48:63], a[208:211], v[116:119], v[48:63]
    v_mfma_f32_32x32x16_bf16 v[64:79], a[212:215], v[112:115], v[64:79]
    v_mfma_f32_32x32x16_bf16 v[80:95], a[212:215], v[116:119], v[80:95]
    v_mfma_f32_16x16x32_bf16 v[184:187], a[208:211], v[28:31], v[184:187]
    v_mfma_f32_16x16x32_bf16 v[188:191], a[212:215], v[28:31], v[188:191]
    ds_read_b128 v[112:115], v17 offset:14848
    ds_read_b128 v[116:119], v17 offset:47616
    s_waitcnt lgkmcnt(8)
    v_mfma_f32_32x32x16_bf16 v[32:47], a[216:219], v[96:99], v[32:47]
    s_add_u32 m0, s74, 67584
    s_add_u32 s80, s80, 16384
    buffer_load_dwordx4 v13, s[48:51], s80 offen lds
    v_mfma_f32_32x32x16_bf16 v[48:63], a[216:219], v[100:103], v[48:63]
    s_waitcnt vmcnt(13)
    ds_read_b64_tr_b16 v[224:225], v15 offset:10240
    ds_read_b64_tr_b16 v[226:227], v15 offset:11264
    v_mfma_f32_32x32x16_bf16 v[64:79], a[220:223], v[96:99], v[64:79]
    buffer_load_dwordx4 v14, s[48:51], s80 offen offset:1024 lds
    v_mfma_f32_32x32x16_bf16 v[80:95], a[220:223], v[100:103], v[80:95]
    ds_read_b64_tr_b16 v[228:229], v16 offset:10240
    ds_read_b64_tr_b16 v[230:231], v16 offset:11264
    v_mfma_f32_16x16x32_bf16 v[184:187], a[216:219], v[28:31], v[184:187]
    v_mfma_f32_16x16x32_bf16 v[188:191], a[220:223], v[28:31], v[188:191]
    ds_read_b128 v[96:99], v17 offset:15360
    ds_read_b128 v[100:103], v17 offset:48128
    s_waitcnt lgkmcnt(8)
    v_mfma_f32_32x32x16_bf16 v[32:47], a[224:227], v[104:107], v[32:47]
    v_mfma_f32_32x32x16_bf16 v[48:63], a[224:227], v[108:111], v[48:63]
    v_mfma_f32_32x32x16_bf16 v[64:79], a[228:231], v[104:107], v[64:79]
    v_mfma_f32_32x32x16_bf16 v[80:95], a[228:231], v[108:111], v[80:95]
    v_mfma_f32_16x16x32_bf16 v[184:187], a[224:227], v[28:31], v[184:187]
HOP59:
    s_cbranch_execz HOP_RET
    v_mfma_f32_16x16x32_bf16 v[188:191], a[228:231], v[28:31], v[188:191]
    ds_read_b128 v[104:107], v17 offset:15872
    ds_read_b128 v[108:111], v17 offset:48640
    s_waitcnt lgkmcnt(8)
    v_mfma_f32_32x32x16_bf16 v[32:47], a[232:235], v[112:115], v[32:47]
    s_add_u32 m0, s74, 69632
    s_bfe_u32 s80, s6, 0x40010
    s_lshl_b32 s80, s80, 15
    buffer_load_dwordx4 v13, s[48:51], s80 offen lds
    v_mfma_f32_32x32x16_bf16 v[48:63], a[232:235], v[116:119], v[48:63]
    s_waitcnt vmcnt(13)
    ds_read_b64_tr_b16 v[232:233], v15 offset:12288
    ds_read_b64_tr_b16 v[234:235], v15 offset:13312
    v_mfma_f32_32x32x16_bf16 v[64:79], a[236:239], v[112:115], v[64:79]
    buffer_load_dwordx4 v14, s[48:51], s80 offen offset:1024 lds
    v_mfma_f32_32x32x16_bf16 v[80:95], a[236:239], v[116:119], v[80:95]
    ds_read_b64_tr_b16 v[236:237], v16 offset:12288
    ds_read_b64_tr_b16 v[238:239], v16 offset:13312
    v_mfma_f32_16x16x32_bf16 v[184:187], a[232:235], v[28:31], v[184:187]
    v_mfma_f32_16x16x32_bf16 v[188:191], a[236:239], v[28:31], v[188:191]
    s_waitcnt lgkmcnt(6)
    v_mfma_f32_32x32x16_bf16 v[32:47], a[240:243], v[96:99], v[32:47]
    v_mfma_f32_32x32x16_bf16 v[48:63], a[240:243], v[100:103], v[48:63]
    v_mfma_f32_32x32x16_bf16 v[64:79], a[244:247], v[96:99], v[64:79]
    v_mfma_f32_32x32x16_bf16 v[80:95], a[244:247], v[100:103], v[80:95]
    v_mfma_f32_16x16x32_bf16 v[184:187], a[240:243], v[28:31], v[184:187]
    v_mfma_f32_16x16x32_bf16 v[188:191], a[244:247], v[28:31], v[188:191]
    s_waitcnt lgkmcnt(4)
    v_mfma_f32_32x32x16_bf16 v[32:47], a[248:251], v[104:107], v[32:47]
    s_add_u32 m0, s74, 71680
    s_add_u32 s80, s80, 16384
    buffer_load_dwordx4 v13, s[48:51], s80 offen lds
    v_mfma_f32_32x32x16_bf16 v[48:63], a[248:251], v[108:111], v[48:63]
HOP60:
    s_cbranch_execz HOP_RET
    s_waitcnt vmcnt(13)
    ds_read_b64_tr_b16 v[240:241], v15 offset:14336
    ds_read_b64_tr_b16 v[242:243], v15 offset:15360
    v_mfma_f32_32x32x16_bf16 v[64:79], a[252:255], v[104:107], v[64:79]
    buffer_load_dwordx4 v14, s[48:51], s80 offen offset:1024 lds
    v_mfma_f32_32x32x16_bf16 v[80:95], a[252:255], v[108:111], v[80:95]
    ds_read_b64_tr_b16 v[244:245], v16 offset:14336
    ds_read_b64_tr_b16 v[246:247], v16 offset:15360
    v_mfma_f32_16x16x32_bf16 v[184:187], a[248:251], v[28:31], v[184:187]
    v_mfma_f32_16x16x32_bf16 v[188:191], a[252:255], v[28:31], v[188:191]
    s_waitcnt lgkmcnt(0)
    s_barrier
    v_and_b32 v5, 31, v0
    v_lshlrev_b32 v5, 4, v5
    v_add_u32 v5, 156160, v5
    ds_read_b128 v[136:139], v5 offset:0
    ds_read_b128 v[140:143], v5 offset:512
    v_and_b32 v4, 1, v0
    v_lshlrev_b32 v4, 6, v4
    v_lshl_add_u32 v4, v3, 4, v4
    s_lshl_b32 s65, s60, 8
    s_add_u32 s65, s65, 157696
    v_add_u32 v4, s65, v4
    ds_write_b128 v4, v[184:187] offset:0
    ds_write_b128 v4, v[188:191] offset:128
    v_lshrrev_b32 v7, 5, v0
    v_lshlrev_b32 v7, 4, v7
    v_add_u32 v7, s65, v7
    ds_read_b128 v[120:123], v7 offset:0
    ds_read_b128 v[124:127], v7 offset:32
    ds_read_b128 v[128:131], v7 offset:64
    ds_read_b128 v[132:135], v7 offset:96
    s_add_u32 m0, s74, 73728
    s_bfe_u32 s80, s6, 0x40014
    s_lshl_b32 s80, s80, 15
    buffer_load_dwordx4 v13, s[48:51], s80 offen lds
    s_sub_u32 s65, s62, s64
    s_and_b32 s65, s65, 7
HOP61:
    s_cbranch_execz HOP_RET
    s_lshl_b32 s65, s65, 1
    s_and_b32 s66, s60, 1
    s_add_u32 s65, s65, s66
    s_lshl_b32 s65, s65, 10
    s_lshr_b32 s66, s60, 1
    s_lshl_b32 s67, s66, 15
    s_add_u32 s65, s65, s67
    v_add_u32 v4, s65, v17
    ds_read_b128 v[160:163], v4 offset:0
    ds_read_b128 v[164:167], v4 offset:512
    s_lshl_b32 s66, s66, 10
    v_add_u32 v8, s66, v10
    v_xor_b32 v9, 0x400, v8
    s_lshr_b32 s65, s62, 1
    s_lshl_b32 s65, s65, 7
    s_and_b32 s66, s62, 1
    s_lshl_b32 s66, s66, 2
    s_add_u32 s66, s66, s60
    s_lshl_b32 s66, s66, 2
    s_add_u32 s65, s65, s66
    s_add_u32 s69, s65, s73
    s_mov_b32 s81, s75
    s_add_u32 s70, s74, 65536
    s_sub_u32 s81, s81, s70
    v_add_u32 v15, s81, v15
    v_add_u32 v16, s81, v16
    s_waitcnt vmcnt(13)
    ds_read_b64_tr_b16 v[248:249], v15 offset:2048
    ds_read_b64_tr_b16 v[250:251], v15 offset:3072
    s_waitcnt lgkmcnt(4)
    v_pk_fma_f32 v[32:33], v[120:121], v[136:137], v[32:33] op_sel:[0,0,0] op_sel_hi:[1,0,1]
    v_pk_fma_f32 v[34:35], v[122:123], v[136:137], v[34:35] op_sel:[0,0,0] op_sel_hi:[1,0,1]
    v_pk_fma_f32 v[36:37], v[124:125], v[136:137], v[36:37] op_sel:[0,0,0] op_sel_hi:[1,0,1]
    v_pk_fma_f32 v[38:39], v[126:127], v[136:137], v[38:39] op_sel:[0,0,0] op_sel_hi:[1,0,1]
    buffer_load_dwordx4 v14, s[48:51], s80 offen offset:1024 lds
    v_pk_fma_f32 v[40:41], v[128:129], v[136:137], v[40:41] op_sel:[0,0,0] op_sel_hi:[1,0,1]
    v_pk_fma_f32 v[42:43], v[130:131], v[136:137], v[42:43] op_sel:[0,0,0] op_sel_hi:[1,0,1]
    v_pk_fma_f32 v[44:45], v[132:133], v[136:137], v[44:45] op_sel:[0,0,0] op_sel_hi:[1,0,1]
    v_pk_fma_f32 v[46:47], v[134:135], v[136:137], v[46:47] op_sel:[0,0,0] op_sel_hi:[1,0,1]
    ds_read_b64_tr_b16 v[252:253], v16 offset:2048
    ds_read_b64_tr_b16 v[254:255], v16 offset:3072
    v_pk_mul_f32 v[144:145], v[32:33], v[32:33]
    v_pk_mul_f32 v[146:147], v[34:35], v[34:35]
HOP62:
    s_cbranch_execz HOP_RET
    v_pk_mul_f32 v[148:149], v[36:37], v[36:37]
    v_pk_mul_f32 v[150:151], v[38:39], v[38:39]
    s_add_u32 m0, s74, 75776
    s_add_u32 s80, s80, 16384
    buffer_load_dwordx4 v13, s[48:51], s80 offen lds
    v_pk_mul_f32 v[152:153], v[40:41], v[40:41]
    v_pk_mul_f32 v[154:155], v[42:43], v[42:43]
    v_pk_mul_f32 v[156:157], v[44:45], v[44:45]
    v_pk_mul_f32 v[158:159], v[46:47], v[46:47]
    s_waitcnt vmcnt(13)
    ds_read_b64_tr_b16 v[168:169], v15 offset:4096
    ds_read_b64_tr_b16 v[170:171], v15 offset:5120
    v_pk_fma_f32 v[144:145], v[144:145], v[138:139], v[136:137] op_sel:[0,0,1] op_sel_hi:[1,0,1]
    v_pk_fma_f32 v[146:147], v[146:147], v[138:139], v[136:137] op_sel:[0,0,1] op_sel_hi:[1,0,1]
    v_pk_fma_f32 v[148:149], v[148:149], v[138:139], v[136:137] op_sel:[0,0,1] op_sel_hi:[1,0,1]
    v_pk_fma_f32 v[150:151], v[150:151], v[138:139], v[136:137] op_sel:[0,0,1] op_sel_hi:[1,0,1]
    buffer_load_dwordx4 v14, s[48:51], s80 offen offset:1024 lds
    v_pk_fma_f32 v[152:153], v[152:153], v[138:139], v[136:137] op_sel:[0,0,1] op_sel_hi:[1,0,1]
    v_pk_fma_f32 v[154:155], v[154:155], v[138:139], v[136:137] op_sel:[0,0,1] op_sel_hi:[1,0,1]
    v_pk_fma_f32 v[156:157], v[156:157], v[138:139], v[136:137] op_sel:[0,0,1] op_sel_hi:[1,0,1]
    v_pk_fma_f32 v[158:159], v[158:159], v[138:139], v[136:137] op_sel:[0,0,1] op_sel_hi:[1,0,1]
    ds_read_b64_tr_b16 v[172:173], v16 offset:4096
    ds_read_b64_tr_b16 v[174:175], v16 offset:5120
    v_pk_mul_f32 v[144:145], v[144:145], v[32:33]
    v_pk_mul_f32 v[146:147], v[146:147], v[34:35]
    v_pk_mul_f32 v[148:149], v[148:149], v[36:37]
    v_pk_mul_f32 v[150:151], v[150:151], v[38:39]
    s_add_u32 m0, s74, 77824
    s_bfe_u32 s80, s6, 0x40018
    s_lshl_b32 s80, s80, 15
    buffer_load_dwordx4 v13, s[48:51], s80 offen lds
    v_pk_mul_f32 v[152:153], v[152:153], v[40:41]
HOP63:
    s_cbranch_execz HOP_RET
    v_pk_mul_f32 v[154:155], v[154:155], v[42:43]
    v_pk_mul_f32 v[156:157], v[156:157], v[44:45]
    v_pk_mul_f32 v[158:159], v[158:159], v[46:47]
    s_waitcnt vmcnt(13)
    ds_read_b64_tr_b16 v[176:177], v15 offset:0
    ds_read_b64_tr_b16 v[178:179], v15 offset:1024
    v_exp_f32 v144, v144
    v_exp_f32 v145, v145
    v_exp_f32 v146, v146
    v_exp_f32 v147, v147
    buffer_load_dwordx4 v14, s[48:51], s80 offen offset:1024 lds
    v_exp_f32 v148, v148
    v_exp_f32 v149, v149
    v_exp_f32 v150, v150
    v_exp_f32 v151, v151
    ds_read_b64_tr_b16 v[180:181], v16 offset:0
    ds_read_b64_tr_b16 v[182:183], v16 offset:1024
    v_exp_f32 v152, v152
    v_exp_f32 v153, v153
    v_exp_f32 v154, v154
    v_exp_f32 v155, v155
    s_add_u32 m0, s74, 79872
    s_add_u32 s80, s80, 16384
    buffer_load_dwordx4 v13, s[48:51], s80 offen lds
    v_exp_f32 v156, v156
    v_exp_f32 v157, v157
    v_exp_f32 v158, v158
    v_exp_f32 v159, v159
    s_add_u32 s81, s74, 65536
    s_mov_b32 s70, s75
    s_sub_u32 s81, s81, s70
    v_add_u32 v15, s81, v15
    v_add_u32 v16, s81, v16
    s_waitcnt vmcnt(13)
    ds_read_b64_tr_b16 a[0:1], v15 offset:0
    ds_read_b64_tr_b16 a[2:3], v15 offset:1024
    s_nop 0
    v_pk_fma_f32 v[144:145], v[144:145], v[138:139], v[138:139] op_sel:[0,1,1] op_sel_hi:[1,1,1]
    v_pk_fma_f32 v[146:147], v[146:147], v[138:139], v[138:139] op_sel:[0,1,1] op_sel_hi:[1,1,1]
    v_pk_fma_f32 v[148:149], v[148:149], v[138:139], v[138:139] op_sel:[0,1,1] op_sel_hi:[1,1,1]
    v_pk_fma_f32 v[150:151], v[150:151], v[138:139], v[138:139] op_sel:[0,1,1] op_sel_hi:[1,1,1]
    buffer_load_dwordx4 v14, s[48:51], s80 offen offset:1024 lds
HOP64:
    s_cbranch_execz HOP_RET
    v_pk_fma_f32 v[152:153], v[152:153], v[138:139], v[138:139] op_sel:[0,1,1] op_sel_hi:[1,1,1]
    v_pk_fma_f32 v[154:155], v[154:155], v[138:139], v[138:139] op_sel:[0,1,1] op_sel_hi:[1,1,1]
    v_pk_fma_f32 v[156:157], v[156:157], v[138:139], v[138:139] op_sel:[0,1,1] op_sel_hi:[1,1,1]
    v_pk_fma_f32 v[158:159], v[158:159], v[138:139], v[138:139] op_sel:[0,1,1] op_sel_hi:[1,1,1]
    ds_read_b64_tr_b16 a[4:5], v16 offset:0
    ds_read_b64_tr_b16 a[6:7], v16 offset:1024
    v_rcp_f32 v144, v144
    v_rcp_f32 v145, v145
    v_rcp_f32 v146, v146
    v_rcp_f32 v147, v147
    s_waitcnt lgkmcnt(12)
    s_add_u32 m0, s75, 2048
    s_bfe_u32 s80, s6, 0x4001c
    s_lshl_b32 s80, s80, 15
    buffer_load_dwordx4 v13, s[48:51], s80 offen lds
    v_rcp_f32 v148, v148
    v_rcp_f32 v149, v149
    v_rcp_f32 v150, v150
    v_rcp_f32 v151, v151
    s_waitcnt vmcnt(13)
    ds_read_b64_tr_b16 a[8:9], v15 offset:2048
    ds_read_b64_tr_b16 a[10:11], v15 offset:3072
    v_rcp_f32 v152, v152
    v_rcp_f32 v153, v153
    v_rcp_f32 v154, v154
    v_rcp_f32 v155, v155
    buffer_load_dwordx4 v14, s[48:51], s80 offen offset:1024 lds
    v_rcp_f32 v156, v156
    v_rcp_f32 v157, v157
    v_rcp_f32 v158, v158
    v_rcp_f32 v159, v159
    ds_read_b64_tr_b16 a[12:13], v16 offset:2048
    ds_read_b64_tr_b16 a[14:15], v16 offset:3072
    s_nop 0
    v_pk_mul_f32 v[32:33], v[32:33], v[144:145]
    v_pk_mul_f32 v[34:35], v[34:35], v[146:147]
    v_pk_mul_f32 v[36:37], v[36:37], v[148:149]
    v_pk_mul_f32 v[38:39], v[38:39], v[150:151]
    s_waitcnt lgkmcnt(12)
    s_add_u32 m0, s75, 4096
    s_add_u32 s80, s80, 16384
HOP65:
    s_cbranch_execz HOP_RET
    buffer_load_dwordx4 v13, s[48:51], s80 offen lds
    v_pk_mul_f32 v[40:41], v[40:41], v[152:153]
    v_pk_mul_f32 v[42:43], v[42:43], v[154:155]
    v_pk_mul_f32 v[44:45], v[44:45], v[156:157]
    v_pk_mul_f32 v[46:47], v[46:47], v[158:159]
    s_waitcnt vmcnt(13)
    ds_read_b64_tr_b16 a[16:17], v15 offset:4096
    ds_read_b64_tr_b16 a[18:19], v15 offset:5120
    v_cvt_pk_bf16_f32 v32, v32, v33
    v_cvt_pk_bf16_f32 v33, v34, v35
    v_cvt_pk_bf16_f32 v34, v36, v37
    v_cvt_pk_bf16_f32 v35, v38, v39
    buffer_load_dwordx4 v14, s[48:51], s80 offen offset:1024 lds
    v_cvt_pk_bf16_f32 v36, v40, v41
    v_cvt_pk_bf16_f32 v37, v42, v43
    v_cvt_pk_bf16_f32 v38, v44, v45
    v_cvt_pk_bf16_f32 v39, v46, v47
    ds_read_b64_tr_b16 a[20:21], v16 offset:4096
    ds_read_b64_tr_b16 a[22:23], v16 offset:5120
    buffer_store_dwordx4 v[32:35], v10, s[56:59], s76 offen offset:0 sc1
    buffer_store_dwordx4 v[36:39], v10, s[56:59], s76 offen offset:2048 sc1
    v_pk_fma_f32 v[48:49], v[120:121], v[140:141], v[48:49] op_sel:[0,0,0] op_sel_hi:[1,0,1]
    v_pk_fma_f32 v[50:51], v[122:123], v[140:141], v[50:51] op_sel:[0,0,0] op_sel_hi:[1,0,1]
    v_pk_fma_f32 v[52:53], v[124:125], v[140:141], v[52:53] op_sel:[0,0,0] op_sel_hi:[1,0,1]
    s_waitcnt lgkmcnt(12)
    s_add_u32 m0, s75, 0
    s_bfe_u32 s80, s8, 0x40008
    s_lshl_b32 s80, s80, 15
    buffer_load_dwordx4 v13, s[48:51], s80 offen lds
    v_pk_fma_f32 v[54:55], v[126:127], v[140:141], v[54:55] op_sel:[0,0,0] op_sel_hi:[1,0,1]
    v_pk_fma_f32 v[56:57], v[128:129], v[140:141], v[56:57] op_sel:[0,0,0] op_sel_hi:[1,0,1]
    v_pk_fma_f32 v[58:59], v[130:131], v[140:141], v[58:59] op_sel:[0,0,0] op_sel_hi:[1,0,1]
    v_pk_fma_f32 v[60:61], v[132:133], v[140:141], v[60:61] op_sel:[0,0,0] op_sel_hi:[1,0,1]
HOP66:
    s_cbranch_execz HOP_RET
    s_waitcnt vmcnt(15)
    ds_read_b64_tr_b16 a[24:25], v15 offset:6144
    ds_read_b64_tr_b16 a[26:27], v15 offset:7168
    v_pk_fma_f32 v[62:63], v[134:135], v[140:141], v[62:63] op_sel:[0,0,0] op_sel_hi:[1,0,1]
    v_pk_mul_f32 v[144:145], v[48:49], v[48:49]
    v_pk_mul_f32 v[146:147], v[50:51], v[50:51]
    v_pk_mul_f32 v[148:149], v[52:53], v[52:53]
    buffer_load_dwordx4 v14, s[48:51], s80 offen offset:1024 lds
    v_pk_mul_f32 v[150:151], v[54:55], v[54:55]
    v_pk_mul_f32 v[152:153], v[56:57], v[56:57]
    v_pk_mul_f32 v[154:155], v[58:59], v[58:59]
    v_pk_mul_f32 v[156:157], v[60:61], v[60:61]
    ds_read_b64_tr_b16 a[28:29], v16 offset:6144
    ds_read_b64_tr_b16 a[30:31], v16 offset:7168
    v_pk_mul_f32 v[158:159], v[62:63], v[62:63]
    v_pk_fma_f32 v[144:145], v[144:145], v[142:143], v[140:141] op_sel:[0,0,1] op_sel_hi:[1,0,1]
    v_pk_fma_f32 v[146:147], v[146:147], v[142:143], v[140:141] op_sel:[0,0,1] op_sel_hi:[1,0,1]
    v_pk_fma_f32 v[148:149], v[148:149], v[142:143], v[140:141] op_sel:[0,0,1] op_sel_hi:[1,0,1]
    s_waitcnt lgkmcnt(12)
    s_add_u32 m0, s74, 65536
    s_add_u32 s80, s80, 16384
    buffer_load_dwordx4 v13, s[48:51], s80 offen lds
    v_pk_fma_f32 v[150:151], v[150:151], v[142:143], v[140:141] op_sel:[0,0,1] op_sel_hi:[1,0,1]
    v_pk_fma_f32 v[152:153], v[152:153], v[142:143], v[140:141] op_sel:[0,0,1] op_sel_hi:[1,0,1]
    v_pk_fma_f32 v[154:155], v[154:155], v[142:143], v[140:141] op_sel:[0,0,1] op_sel_hi:[1,0,1]
    v_pk_fma_f32 v[156:157], v[156:157], v[142:143], v[140:141] op_sel:[0,0,1] op_sel_hi:[1,0,1]
    s_waitcnt vmcnt(15)
    ds_read_b64_tr_b16 a[32:33], v15 offset:8192
    ds_read_b64_tr_b16 a[34:35], v15 offset:9216
    v_pk_fma_f32 v[158:159], v[158:159], v[142:143], v[140:141] op_sel:[0,0,1] op_sel_hi:[1,0,1]
    v_pk_mul_f32 v[144:145], v[144:145], v[48:49]
    v_pk_mul_f32 v[146:147], v[146:147], v[50:51]
HOP67:
    s_cbranch_execz HOP_RET
    v_pk_mul_f32 v[148:149], v[148:149], v[52:53]
    buffer_load_dwordx4 v14, s[48:51], s80 offen offset:1024 lds
    v_pk_mul_f32 v[150:151], v[150:151], v[54:55]
    v_pk_mul_f32 v[152:153], v[152:153], v[56:57]
    v_pk_mul_f32 v[154:155], v[154:155], v[58:59]
    v_pk_mul_f32 v[156:157], v[156:157], v[60:61]
    ds_read_b64_tr_b16 a[36:37], v16 offset:8192
    ds_read_b64_tr_b16 a[38:39], v16 offset:9216
    v_pk_mul_f32 v[158:159], v[158:159], v[62:63]
    v_exp_f32 v144, v144
    v_exp_f32 v145, v145
    v_exp_f32 v146, v146
    s_waitcnt lgkmcnt(12)
    s_add_u32 m0, s74, 67584
    s_bfe_u32 s80, s8, 0x4000c
    s_lshl_b32 s80, s80, 15
    buffer_load_dwordx4 v13, s[48:51], s80 offen lds
    v_exp_f32 v147, v147
    v_exp_f32 v148, v148
    v_exp_f32 v149, v149
    v_exp_f32 v150, v150
    s_waitcnt vmcnt(15)
    ds_read_b64_tr_b16 a[40:41], v15 offset:10240
    ds_read_b64_tr_b16 a[42:43], v15 offset:11264
    v_exp_f32 v151, v151
    v_exp_f32 v152, v152
    v_exp_f32 v153, v153
    v_exp_f32 v154, v154
    buffer_load_dwordx4 v14, s[48:51], s80 offen offset:1024 lds
    v_exp_f32 v155, v155
    v_exp_f32 v156, v156
    v_exp_f32 v157, v157
    v_exp_f32 v158, v158
    ds_read_b64_tr_b16 a[44:45], v16 offset:10240
    ds_read_b64_tr_b16 a[46:47], v16 offset:11264
    v_exp_f32 v159, v159
    s_nop 0
    v_pk_fma_f32 v[144:145], v[144:145], v[142:143], v[142:143] op_sel:[0,1,1] op_sel_hi:[1,1,1]
    v_pk_fma_f32 v[146:147], v[146:147], v[142:143], v[142:143] op_sel:[0,1,1] op_sel_hi:[1,1,1]
    v_pk_fma_f32 v[148:149], v[148:149], v[142:143], v[142:143] op_sel:[0,1,1] op_sel_hi:[1,1,1]
    s_waitcnt lgkmcnt(12)
HOP68:
    s_cbranch_execz HOP_RET
    s_add_u32 m0, s74, 69632
    s_add_u32 s80, s80, 16384
    buffer_load_dwordx4 v13, s[48:51], s80 offen lds
    v_pk_fma_f32 v[150:151], v[150:151], v[142:143], v[142:143] op_sel:[0,1,1] op_sel_hi:[1,1,1]
    v_pk_fma_f32 v[152:153], v[152:153], v[142:143], v[142:143] op_sel:[0,1,1] op_sel_hi:[1,1,1]
    v_pk_fma_f32 v[154:155], v[154:155], v[142:143], v[142:143] op_sel:[0,1,1] op_sel_hi:[1,1,1]
    v_pk_fma_f32 v[156:157], v[156:157], v[142:143], v[142:143] op_sel:[0,1,1] op_sel_hi:[1,1,1]
    s_waitcnt vmcnt(15)
    ds_read_b64_tr_b16 a[48:49], v15 offset:12288
    ds_read_b64_tr_b16 a[50:51], v15 offset:13312
    v_pk_fma_f32 v[158:159], v[158:159], v[142:143], v[142:143] op_sel:[0,1,1] op_sel_hi:[1,1,1]
    v_rcp_f32 v144, v144
    v_rcp_f32 v145, v145
    v_rcp_f32 v146, v146
    buffer_load_dwordx4 v14, s[48:51], s80 offen offset:1024 lds
    v_rcp_f32 v147, v147
    v_rcp_f32 v148, v148
    v_rcp_f32 v149, v149
    v_rcp_f32 v150, v150
    ds_read_b64_tr_b16 a[52:53], v16 offset:12288
    ds_read_b64_tr_b16 a[54:55], v16 offset:13312
    v_rcp_f32 v151, v151
    v_rcp_f32 v152, v152
    v_rcp_f32 v153, v153
    v_rcp_f32 v154, v154
    s_waitcnt lgkmcnt(12)
    s_add_u32 m0, s74, 71680
    s_bfe_u32 s80, s8, 0x40010
    s_lshl_b32 s80, s80, 15
    buffer_load_dwordx4 v13, s[48:51], s80 offen lds
    v_rcp_f32 v155, v155
    v_rcp_f32 v156, v156
    v_rcp_f32 v157, v157
    v_rcp_f32 v158, v158
    s_waitcnt vmcnt(15)
    ds_read_b64_tr_b16 a[56:57], v15 offset:14336
    ds_read_b64_tr_b16 a[58:59], v15 offset:15360
    v_rcp_f32 v159, v159
    s_nop 0
    v_pk_mul_f32 v[48:49], v[48:49], v[144:145]
    v_pk_mul_f32 v[50:51], v[50:51], v[146:147]
HOP69:
    s_cbranch_execz HOP_RET
    v_pk_mul_f32 v[52:53], v[52:53], v[148:149]
    buffer_load_dwordx4 v14, s[48:51], s80 offen offset:1024 lds
    v_pk_mul_f32 v[54:55], v[54:55], v[150:151]
    v_pk_mul_f32 v[56:57], v[56:57], v[152:153]
    v_pk_mul_f32 v[58:59], v[58:59], v[154:155]
    v_pk_mul_f32 v[60:61], v[60:61], v[156:157]
    ds_read_b64_tr_b16 a[60:61], v16 offset:14336
    ds_read_b64_tr_b16 a[62:63], v16 offset:15360
    v_pk_mul_f32 v[62:63], v[62:63], v[158:159]
    ds_read_b128 v[120:123], v7 offset:128
    ds_read_b128 v[124:127], v7 offset:160
    ds_read_b128 v[128:131], v7 offset:192
    ds_read_b128 v[132:135], v7 offset:224
    v_cvt_pk_bf16_f32 v48, v48, v49
    v_cvt_pk_bf16_f32 v49, v50, v51
    v_cvt_pk_bf16_f32 v50, v52, v53
    s_waitcnt lgkmcnt(15)
    s_add_u32 m0, s74, 73728
    s_add_u32 s80, s80, 16384
    buffer_load_dwordx4 v13, s[48:51], s80 offen lds
    v_cvt_pk_bf16_f32 v51, v54, v55
    v_cvt_pk_bf16_f32 v52, v56, v57
    v_cvt_pk_bf16_f32 v53, v58, v59
    v_cvt_pk_bf16_f32 v54, v60, v61
    s_mov_b32 s81, s75
    s_add_u32 s70, s74, 65536
    s_sub_u32 s81, s81, s70
    v_add_u32 v15, s81, v15
    v_add_u32 v16, s81, v16
    s_waitcnt vmcnt(15)
    ds_read_b64_tr_b16 a[64:65], v15 offset:2048
    ds_read_b64_tr_b16 a[66:67], v15 offset:3072
    v_cvt_pk_bf16_f32 v55, v62, v63
    buffer_store_dwordx4 v[48:51], v10, s[56:59], s76 offen offset:1024 sc1
HOP70:
    s_cbranch_execz HOP_RET
    buffer_store_dwordx4 v[52:55], v10, s[56:59], s76 offen offset:3072 sc1
    s_waitcnt lgkmcnt(2)
    v_pk_fma_f32 v[64:65], v[120:121], v[136:137], v[64:65] op_sel:[0,0,0] op_sel_hi:[1,0,1]
    v_pk_fma_f32 v[66:67], v[122:123], v[136:137], v[66:67] op_sel:[0,0,0] op_sel_hi:[1,0,1]
    buffer_load_dwordx4 v14, s[48:51], s80 offen offset:1024 lds
    v_pk_fma_f32 v[68:69], v[124:125], v[136:137], v[68:69] op_sel:[0,0,0] op_sel_hi:[1,0,1]
    v_pk_fma_f32 v[70:71], v[126:127], v[136:137], v[70:71] op_sel:[0,0,0] op_sel_hi:[1,0,1]
    v_pk_fma_f32 v[72:73], v[128:129], v[136:137], v[72:73] op_sel:[0,0,0] op_sel_hi:[1,0,1]
    v_pk_fma_f32 v[74:75], v[130:131], v[136:137], v[74:75] op_sel:[0,0,0] op_sel_hi:[1,0,1]
    ds_read_b64_tr_b16 a[68:69], v16 offset:2048
    ds_read_b64_tr_b16 a[70:71], v16 offset:3072
    v_pk_fma_f32 v[76:77], v[132:133], v[136:137], v[76:77] op_sel:[0,0,0] op_sel_hi:[1,0,1]
    v_pk_fma_f32 v[78:79], v[134:135], v[136:137], v[78:79] op_sel:[0,0,0] op_sel_hi:[1,0,1]
    v_pk_mul_f32 v[144:145], v[64:65], v[64:65]
    v_pk_mul_f32 v[146:147], v[66:67], v[66:67]
    s_add_u32 m0, s74, 75776
    s_bfe_u32 s80, s8, 0x40014
    s_lshl_b32 s80, s80, 15
    buffer_load_dwordx4 v13, s[48:51], s80 offen lds
    v_pk_mul_f32 v[148:149], v[68:69], v[68:69]
    v_pk_mul_f32 v[150:151], v[70:71], v[70:71]
    v_pk_mul_f32 v[152:153], v[72:73], v[72:73]
    v_pk_mul_f32 v[154:155], v[74:75], v[74:75]
    s_waitcnt vmcnt(17)
    ds_read_b64_tr_b16 a[72:73], v15 offset:4096
    ds_read_b64_tr_b16 a[74:75], v15 offset:5120
    v_pk_mul_f32 v[156:157], v[76:77], v[76:77]
    v_pk_mul_f32 v[158:159], v[78:79], v[78:79]
    v_pk_fma_f32 v[144:145], v[144:145], v[138:139], v[136:137] op_sel:[0,0,1] op_sel_hi:[1,0,1]
    v_pk_fma_f32 v[146:147], v[146:147], v[138:139], v[136:137] op_sel:[0,0,1] op_sel_hi:[1,0,1]
    buffer_load_dwordx4 v14, s[48:51], s80 offen offset:1024 lds
    v_pk_fma_f32 v[148:149], v[148:149], v[138:139], v[136:137] op_sel:[0,0,1] op_sel_hi:[1,0,1]
HOP71:
    s_cbranch_execz HOP_RET
    v_pk_fma_f32 v[150:151], v[150:151], v[138:139], v[136:137] op_sel:[0,0,1] op_sel_hi:[1,0,1]
    v_pk_fma_f32 v[152:153], v[152:153], v[138:139], v[136:137] op_sel:[0,0,1] op_sel_hi:[1,0,1]
    v_pk_fma_f32 v[154:155], v[154:155], v[138:139], v[136:137] op_sel:[0,0,1] op_sel_hi:[1,0,1]
    ds_read_b64_tr_b16 a[76:77], v16 offset:4096
    ds_read_b64_tr_b16 a[78:79], v16 offset:5120
    v_pk_fma_f32 v[156:157], v[156:157], v[138:139], v[136:137] op_sel:[0,0,1] op_sel_hi:[1,0,1]
    v_pk_fma_f32 v[158:159], v[158:159], v[138:139], v[136:137] op_sel:[0,0,1] op_sel_hi:[1,0,1]
    v_pk_mul_f32 v[144:145], v[144:145], v[64:65]
    v_pk_mul_f32 v[146:147], v[146:147], v[66:67]
    s_add_u32 m0, s74, 77824
    s_add_u32 s80, s80, 16384
    buffer_load_dwordx4 v13, s[48:51], s80 offen lds
    v_pk_mul_f32 v[148:149], v[148:149], v[68:69]
    v_pk_mul_f32 v[150:151], v[150:151], v[70:71]
    v_pk_mul_f32 v[152:153], v[152:153], v[72:73]
    v_pk_mul_f32 v[154:155], v[154:155], v[74:75]
    s_waitcnt vmcnt(15)
    ds_read_b64_tr_b16 a[80:81], v15 offset:0
    ds_read_b64_tr_b16 a[82:83], v15 offset:1024
    v_pk_mul_f32 v[156:157], v[156:157], v[76:77]
    v_pk_mul_f32 v[158:159], v[158:159], v[78:79]
    v_exp_f32 v144, v144
    v_exp_f32 v145, v145
    buffer_load_dwordx4 v14, s[48:51], s80 offen offset:1024 lds
    v_exp_f32 v146, v146
    v_exp_f32 v147, v147
    v_exp_f32 v148, v148
    v_exp_f32 v149, v149
    ds_read_b64_tr_b16 a[84:85], v16 offset:0
    ds_read_b64_tr_b16 a[86:87], v16 offset:1024
    v_exp_f32 v150, v150
    v_exp_f32 v151, v151
    v_exp_f32 v152, v152
    v_exp_f32 v153, v153
    s_add_u32 s81, s74, 65536
    s_mov_b32 s70, s75
    s_sub_u32 s81, s81, s70
HOP72:
    s_cbranch_execz HOP_RET
    v_add_u32 v15, s81, v15
    v_add_u32 v16, s81, v16
    s_waitcnt vmcnt(14)
    ds_read_b64_tr_b16 a[88:89], v15 offset:0
    ds_read_b64_tr_b16 a[90:91], v15 offset:1024
    v_exp_f32 v154, v154
    v_exp_f32 v155, v155
    v_exp_f32 v156, v156
    v_exp_f32 v157, v157
    ds_read_b64_tr_b16 a[92:93], v16 offset:0
    ds_read_b64_tr_b16 a[94:95], v16 offset:1024
    v_exp_f32 v158, v158
    v_exp_f32 v159, v159
    s_nop 0
    v_pk_fma_f32 v[144:145], v[144:145], v[138:139], v[138:139] op_sel:[0,1,1] op_sel_hi:[1,1,1]
    v_pk_fma_f32 v[146:147], v[146:147], v[138:139], v[138:139] op_sel:[0,1,1] op_sel_hi:[1,1,1]
    v_pk_fma_f32 v[148:149], v[148:149], v[138:139], v[138:139] op_sel:[0,1,1] op_sel_hi:[1,1,1]
    v_pk_fma_f32 v[150:151], v[150:151], v[138:139], v[138:139] op_sel:[0,1,1] op_sel_hi:[1,1,1]
    v_pk_fma_f32 v[152:153], v[152:153], v[138:139], v[138:139] op_sel:[0,1,1] op_sel_hi:[1,1,1]
    v_pk_fma_f32 v[154:155], v[154:155], v[138:139], v[138:139] op_sel:[0,1,1] op_sel_hi:[1,1,1]
    s_waitcnt vmcnt(5)
    s_mov_b64 exec, 1
    s_cmp_eq_u32 s13, 0
    s_cbranch_scc1 XS_20
    buffer_store_dword v21, off, s[56:59], s69 offset:32
XS_20_r:
    s_mov_b64 exec, -1
    v_pk_fma_f32 v[156:157], v[156:157], v[138:139], v[138:139] op_sel:[0,1,1] op_sel_hi:[1,1,1]
    v_pk_fma_f32 v[158:159], v[158:159], v[138:139], v[138:139] op_sel:[0,1,1] op_sel_hi:[1,1,1]
    v_rcp_f32 v144, v144
    v_rcp_f32 v145, v145
    ds_read_b64_tr_b16 a[96:97], v15 offset:2048
    ds_read_b64_tr_b16 a[98:99], v15 offset:3072
    v_rcp_f32 v146, v146
    v_rcp_f32 v147, v147
    v_rcp_f32 v148, v148
    v_rcp_f32 v149, v149
    ds_read_b64_tr_b16 a[100:101], v16 offset:2048
    ds_read_b64_tr_b16 a[102:103], v16 offset:3072
    v_rcp_f32 v150, v150
    v_rcp_f32 v151, v151
    v_rcp_f32 v152, v152
    v_rcp_f32 v153, v153
    v_rcp_f32 v154, v154
    v_rcp_f32 v155, v155
HOP73:
    s_cbranch_execz HOP_RET
    v_rcp_f32 v156, v156
    v_rcp_f32 v157, v157
    v_rcp_f32 v158, v158
    v_rcp_f32 v159, v159
    s_nop 0
    v_pk_mul_f32 v[64:65], v[64:65], v[144:145]
    v_pk_mul_f32 v[66:67], v[66:67], v[146:147]
    ds_read_b64_tr_b16 a[104:105], v15 offset:4096
    ds_read_b64_tr_b16 a[106:107], v15 offset:5120
    v_pk_mul_f32 v[68:69], v[68:69], v[148:149]
    v_pk_mul_f32 v[70:71], v[70:71], v[150:151]
    v_pk_mul_f32 v[72:73], v[72:73], v[152:153]
    v_pk_mul_f32 v[74:75], v[74:75], v[154:155]
    ds_read_b64_tr_b16 a[108:109], v16 offset:4096
    ds_read_b64_tr_b16 a[110:111], v16 offset:5120
    v_pk_mul_f32 v[76:77], v[76:77], v[156:157]
    v_pk_mul_f32 v[78:79], v[78:79], v[158:159]
    v_cvt_pk_bf16_f32 v64, v64, v65
    v_cvt_pk_bf16_f32 v65, v66, v67
    v_cvt_pk_bf16_f32 v66, v68, v69
    v_cvt_pk_bf16_f32 v67, v70, v71
    v_cvt_pk_bf16_f32 v68, v72, v73
    v_cvt_pk_bf16_f32 v69, v74, v75
    v_cvt_pk_bf16_f32 v70, v76, v77
    v_cvt_pk_bf16_f32 v71, v78, v79
    buffer_store_dwordx4 v[64:67], v10, s[56:59], s77 offen offset:0 sc1
    buffer_store_dwordx4 v[68:71], v10, s[56:59], s77 offen offset:2048 sc1
    v_pk_fma_f32 v[80:81], v[120:121], v[140:141], v[80:81] op_sel:[0,0,0] op_sel_hi:[1,0,1]
    ds_read_b64_tr_b16 a[112:113], v15 offset:6144
    ds_read_b64_tr_b16 a[114:115], v15 offset:7168
    v_pk_fma_f32 v[82:83], v[122:123], v[140:141], v[82:83] op_sel:[0,0,0] op_sel_hi:[1,0,1]
    v_pk_fma_f32 v[84:85], v[124:125], v[140:141], v[84:85] op_sel:[0,0,0] op_sel_hi:[1,0,1]
    v_pk_fma_f32 v[86:87], v[126:127], v[140:141], v[86:87] op_sel:[0,0,0] op_sel_hi:[1,0,1]
HOP74:
    s_cbranch_execz HOP_RET
    v_pk_fma_f32 v[88:89], v[128:129], v[140:141], v[88:89] op_sel:[0,0,0] op_sel_hi:[1,0,1]
    ds_read_b64_tr_b16 a[116:117], v16 offset:6144
    ds_read_b64_tr_b16 a[118:119], v16 offset:7168
    v_pk_fma_f32 v[90:91], v[130:131], v[140:141], v[90:91] op_sel:[0,0,0] op_sel_hi:[1,0,1]
    v_pk_fma_f32 v[92:93], v[132:133], v[140:141], v[92:93] op_sel:[0,0,0] op_sel_hi:[1,0,1]
    v_pk_fma_f32 v[94:95], v[134:135], v[140:141], v[94:95] op_sel:[0,0,0] op_sel_hi:[1,0,1]
    v_pk_mul_f32 v[144:145], v[80:81], v[80:81]
    v_pk_mul_f32 v[146:147], v[82:83], v[82:83]
    v_pk_mul_f32 v[148:149], v[84:85], v[84:85]
    v_pk_mul_f32 v[150:151], v[86:87], v[86:87]
    v_pk_mul_f32 v[152:153], v[88:89], v[88:89]
    buffer_load_dword v1, v20, s[56:59], s73 offen offset:32 sc1
    v_pk_mul_f32 v[154:155], v[90:91], v[90:91]
    v_pk_mul_f32 v[156:157], v[92:93], v[92:93]
    v_pk_mul_f32 v[158:159], v[94:95], v[94:95]
    v_pk_fma_f32 v[144:145], v[144:145], v[142:143], v[140:141] op_sel:[0,0,1] op_sel_hi:[1,0,1]
    s_waitcnt vmcnt(8)
    ds_read_b64_tr_b16 a[120:121], v15 offset:8192
    ds_read_b64_tr_b16 a[122:123], v15 offset:9216
    v_pk_fma_f32 v[146:147], v[146:147], v[142:143], v[140:141] op_sel:[0,0,1] op_sel_hi:[1,0,1]
    v_pk_fma_f32 v[148:149], v[148:149], v[142:143], v[140:141] op_sel:[0,0,1] op_sel_hi:[1,0,1]
    v_pk_fma_f32 v[150:151], v[150:151], v[142:143], v[140:141] op_sel:[0,0,1] op_sel_hi:[1,0,1]
    v_pk_fma_f32 v[152:153], v[152:153], v[142:143], v[140:141] op_sel:[0,0,1] op_sel_hi:[1,0,1]
    ds_read_b64_tr_b16 a[124:125], v16 offset:8192
    ds_read_b64_tr_b16 a[126:127], v16 offset:9216
    v_pk_fma_f32 v[154:155], v[154:155], v[142:143], v[140:141] op_sel:[0,0,1] op_sel_hi:[1,0,1]
    v_pk_fma_f32 v[156:157], v[156:157], v[142:143], v[140:141] op_sel:[0,0,1] op_sel_hi:[1,0,1]
    v_pk_fma_f32 v[158:159], v[158:159], v[142:143], v[140:141] op_sel:[0,0,1] op_sel_hi:[1,0,1]
    v_pk_mul_f32 v[144:145], v[144:145], v[80:81]
    v_pk_mul_f32 v[146:147], v[146:147], v[82:83]
    v_pk_mul_f32 v[148:149], v[148:149], v[84:85]
HOP75:
    s_cbranch_execz HOP_RET
    v_pk_mul_f32 v[150:151], v[150:151], v[86:87]
    v_pk_mul_f32 v[152:153], v[152:153], v[88:89]
    v_pk_mul_f32 v[154:155], v[154:155], v[90:91]
    v_pk_mul_f32 v[156:157], v[156:157], v[92:93]
    v_pk_mul_f32 v[158:159], v[158:159], v[94:95]
    v_exp_f32 v144, v144
    s_waitcnt vmcnt(6)
    ds_read_b64_tr_b16 a[128:129], v15 offset:10240
    ds_read_b64_tr_b16 a[130:131], v15 offset:11264
    v_exp_f32 v145, v145
    v_exp_f32 v146, v146
    v_exp_f32 v147, v147
    v_exp_f32 v148, v148
    ds_read_b64_tr_b16 a[132:133], v16 offset:10240
    ds_read_b64_tr_b16 a[134:135], v16 offset:11264
    v_exp_f32 v149, v149
    v_exp_f32 v150, v150
    v_exp_f32 v151, v151
    v_exp_f32 v152, v152
    v_exp_f32 v153, v153
    v_exp_f32 v154, v154
    v_exp_f32 v155, v155
    v_exp_f32 v156, v156
    s_waitcnt vmcnt(0)
POLL_21:
    v_cmp_ne_u32 vcc, s63, v1
    s_nop 0
    s_cbranch_vccz POLL_21_d
    s_cmp_eq_u32 s78, 0
    s_cbranch_scc1 POLL_21_d
    s_sub_u32 s78, s78, 1
    s_sleep 1
    buffer_load_dword v1, v20, s[56:59], s73 offen offset:32 sc1
    s_waitcnt vmcnt(0)
    s_branch POLL_21
POLL_21_d:
    v_exp_f32 v157, v157
    v_exp_f32 v158, v158
    v_exp_f32 v159, v159
    s_nop 0
    v_pk_fma_f32 v[144:145], v[144:145], v[142:143], v[142:143] op_sel:[0,1,1] op_sel_hi:[1,1,1]
    s_bfe_u32 s83, s6, 0x40000
    s_lshl_b32 s83, s83, 12
    s_add_u32 s83, s83, s10
    buffer_load_dwordx4 v[96:99], v8, s[56:59], s83 offen offset:0 sc1
    v_pk_fma_f32 v[146:147], v[146:147], v[142:143], v[142:143] op_sel:[0,1,1] op_sel_hi:[1,1,1]
    v_pk_fma_f32 v[148:149], v[148:149], v[142:143], v[142:143] op_sel:[0,1,1] op_sel_hi:[1,1,1]
    v_pk_fma_f32 v[150:151], v[150:151], v[142:143], v[142:143] op_sel:[0,1,1] op_sel_hi:[1,1,1]
HOP76:
    s_cbranch_execz HOP_RET
    v_pk_fma_f32 v[152:153], v[152:153], v[142:143], v[142:143] op_sel:[0,1,1] op_sel_hi:[1,1,1]
    buffer_load_dwordx4 v[100:103], v9, s[56:59], s83 offen offset:0 sc1
    v_pk_fma_f32 v[154:155], v[154:155], v[142:143], v[142:143] op_sel:[0,1,1] op_sel_hi:[1,1,1]
    v_pk_fma_f32 v[156:157], v[156:157], v[142:143], v[142:143] op_sel:[0,1,1] op_sel_hi:[1,1,1]
    v_pk_fma_f32 v[158:159], v[158:159], v[142:143], v[142:143] op_sel:[0,1,1] op_sel_hi:[1,1,1]
    v_rcp_f32 v144, v144
    ds_read_b64_tr_b16 a[136:137], v15 offset:12288
    ds_read_b64_tr_b16 a[138:139], v15 offset:13312
    v_rcp_f32 v145, v145
    v_rcp_f32 v146, v146
    v_rcp_f32 v147, v147
    v_rcp_f32 v148, v148
    ds_read_b64_tr_b16 a[140:141], v16 offset:12288
    ds_read_b64_tr_b16 a[142:143], v16 offset:13312
    v_rcp_f32 v149, v149
    v_rcp_f32 v150, v150
    v_rcp_f32 v151, v151
    v_rcp_f32 v152, v152
    buffer_load_dwordx4 v[104:107], v8, s[56:59], s83 offen offset:2048 sc1
    v_rcp_f32 v153, v153
    v_rcp_f32 v154, v154
    v_rcp_f32 v155, v155
    v_rcp_f32 v156, v156
    buffer_load_dwordx4 v[108:111], v9, s[56:59], s83 offen offset:2048 sc1
    v_rcp_f32 v157, v157
    v_rcp_f32 v158, v158
    v_rcp_f32 v159, v159
    s_nop 0
    v_pk_mul_f32 v[80:81], v[80:81], v[144:145]
    v_pk_mul_f32 v[82:83], v[82:83], v[146:147]
    v_pk_mul_f32 v[84:85], v[84:85], v[148:149]
    v_pk_mul_f32 v[86:87], v[86:87], v[150:151]
    v_pk_mul_f32 v[88:89], v[88:89], v[152:153]
    v_pk_mul_f32 v[90:91], v[90:91], v[154:155]
    v_pk_mul_f32 v[92:93], v[92:93], v[156:157]
    v_pk_mul_f32 v[94:95], v[94:95], v[158:159]
    v_cvt_pk_bf16_f32 v80, v80, v81
    s_bfe_u32 s83, s6, 0x40004
    s_lshl_b32 s83, s83, 12
    s_add_u32 s83, s83, s10
HOP77:
    s_cbranch_execz HOP_RET
    buffer_load_dwordx4 v[112:115], v8, s[56:59], s83 offen offset:0 sc1
    v_cvt_pk_bf16_f32 v81, v82, v83
    v_cvt_pk_bf16_f32 v82, v84, v85
    v_cvt_pk_bf16_f32 v83, v86, v87
    v_cvt_pk_bf16_f32 v84, v88, v89
    buffer_load_dwordx4 v[116:119], v9, s[56:59], s83 offen offset:0 sc1
    v_cvt_pk_bf16_f32 v85, v90, v91
    v_cvt_pk_bf16_f32 v86, v92, v93
    v_cvt_pk_bf16_f32 v87, v94, v95
    buffer_store_dwordx4 v[80:83], v10, s[56:59], s77 offen offset:1024 sc1
    buffer_store_dwordx4 v[84:87], v10, s[56:59], s77 offen offset:3072 sc1
    buffer_load_dwordx4 v[40:43], v8, s[56:59], s83 offen offset:2048 sc1
    buffer_load_dwordx4 v[44:47], v9, s[56:59], s83 offen offset:2048 sc1
    s_bfe_u32 s83, s6, 0x40008
    s_lshl_b32 s83, s83, 12
    s_add_u32 s83, s83, s10
    buffer_load_dwordx4 v[32:35], v8, s[56:59], s83 offen offset:0 sc1
    buffer_load_dwordx4 v[36:39], v9, s[56:59], s83 offen offset:0 sc1
    buffer_load_dwordx4 v[56:59], v8, s[56:59], s83 offen offset:2048 sc1
    buffer_load_dwordx4 v[60:63], v9, s[56:59], s83 offen offset:2048 sc1
    s_waitcnt vmcnt(12)
    v_mfma_f32_32x32x16_bf16 a[144:159], v[192:195], v[96:99], 0
    s_bfe_u32 s83, s6, 0x4000c
    s_lshl_b32 s83, s83, 12
    s_add_u32 s83, s83, s10
    buffer_load_dwordx4 v[48:51], v8, s[56:59], s83 offen offset:0 sc1
    v_mfma_f32_32x32x16_bf16 a[160:175], v[196:199], v[96:99], 0
    v_mfma_f32_32x32x16_bf16 a[176:191], v[192:195], v[100:103], 0
    buffer_load_dwordx4 v[52:55], v9, s[56:59], s83 offen offset:0 sc1
    v_mfma_f32_32x32x16_bf16 a[192:207], v[196:199], v[100:103], 0
    s_waitcnt vmcnt(12)
    s_waitcnt vmcnt(8)
    s_mov_b64 exec, 1
    s_cmp_eq_u32 s13, 0
    s_cbranch_scc1 XS_22
    buffer_store_dword v21, off, s[56:59], s69 offset:64
HOP78:
    s_cbranch_execz HOP_RET
XS_22_r:
    s_mov_b64 exec, -1
    v_mfma_f32_32x32x16_bf16 a[144:159], v[200:203], v[104:107], a[144:159]
    buffer_load_dwordx4 v[72:75], v8, s[56:59], s83 offen offset:2048 sc1
    v_mfma_f32_32x32x16_bf16 a[160:175], v[204:207], v[104:107], a[160:175]
    v_mfma_f32_32x32x16_bf16 a[176:191], v[200:203], v[108:111], a[176:191]
    buffer_load_dwordx4 v[76:79], v9, s[56:59], s83 offen offset:2048 sc1
    v_mfma_f32_32x32x16_bf16 a[192:207], v[204:207], v[108:111], a[192:207]
    v_mfma_f32_32x32x16_bf16 a[144:159], v[208:211], v[112:115], a[144:159]
    s_bfe_u32 s83, s6, 0x40010
    s_lshl_b32 s83, s83, 12
    s_add_u32 s83, s83, s10
    buffer_load_dwordx4 v[64:67], v8, s[56:59], s83 offen offset:0 sc1
    v_mfma_f32_32x32x16_bf16 a[160:175], v[212:215], v[112:115], a[160:175]
    v_mfma_f32_32x32x16_bf16 a[176:191], v[208:211], v[116:119], a[176:191]
    buffer_load_dwordx4 v[68:71], v9, s[56:59], s83 offen offset:0 sc1
    v_mfma_f32_32x32x16_bf16 a[192:207], v[212:215], v[116:119], a[192:207]
    s_waitcnt vmcnt(11)
    v_mfma_f32_32x32x16_bf16 a[144:159], v[216:219], v[40:43], a[144:159]
    buffer_load_dwordx4 v[88:91], v8, s[56:59], s83 offen offset:2048 sc1
    v_mfma_f32_32x32x16_bf16 a[160:175], v[220:223], v[40:43], a[160:175]
    v_mfma_f32_32x32x16_bf16 a[176:191], v[216:219], v[44:47], a[176:191]
    buffer_load_dwordx4 v[92:95], v9, s[56:59], s83 offen offset:2048 sc1
    v_mfma_f32_32x32x16_bf16 a[192:207], v[220:223], v[44:47], a[192:207]
    s_waitcnt vmcnt(11)
    v_mfma_f32_32x32x16_bf16 a[144:159], v[168:171], v[32:35], a[144:159]
    s_bfe_u32 s83, s6, 0x40014
    s_lshl_b32 s83, s83, 12
    s_add_u32 s83, s83, s10
    buffer_load_dwordx4 v[80:83], v8, s[56:59], s83 offen offset:0 sc1
    v_mfma_f32_32x32x16_bf16 a[160:175], v[172:175], v[32:35], a[160:175]
    v_mfma_f32_32x32x16_bf16 a[176:191], v[168:171], v[36:39], a[176:191]
    buffer_load_dwordx4 v[84:87], v9, s[56:59], s83 offen offset:0 sc1
    v_mfma_f32_32x32x16_bf16 a[192:207], v[172:175], v[36:39], a[192:207]
    s_waitcnt vmcnt(11)
    v_mfma_f32_32x32x16_bf16 a[144:159], v[176:179], v[56:59], a[144:159]
HOP79:
    s_cbranch_execz HOP_RET
    buffer_load_dwordx4 v[120:123], v8, s[56:59], s83 offen offset:2048 sc1
    v_mfma_f32_32x32x16_bf16 a[160:175], v[180:183], v[56:59], a[160:175]
    v_mfma_f32_32x32x16_bf16 a[176:191], v[176:179], v[60:63], a[176:191]
    buffer_load_dwordx4 v[124:127], v9, s[56:59], s83 offen offset:2048 sc1
    v_mfma_f32_32x32x16_bf16 a[192:207], v[180:183], v[60:63], a[192:207]
    s_waitcnt vmcnt(11)
    buffer_load_dword v1, v20, s[56:59], s73 offen offset:64 sc1
    v_mfma_f32_32x32x16_bf16 a[144:159], a[0:3], v[48:51], a[144:159]
    s_bfe_u32 s83, s6, 0x40018
    s_lshl_b32 s83, s83, 12
    s_add_u32 s83, s83, s10
    buffer_load_dwordx4 v[128:131], v8, s[56:59], s83 offen offset:0 sc1
    v_mfma_f32_32x32x16_bf16 a[160:175], a[4:7], v[48:51], a[160:175]
    v_mfma_f32_32x32x16_bf16 a[176:191], a[0:3], v[52:55], a[176:191]
    buffer_load_dwordx4 v[132:135], v9, s[56:59], s83 offen offset:0 sc1
    v_mfma_f32_32x32x16_bf16 a[192:207], a[4:7], v[52:55], a[192:207]
    s_waitcnt vmcnt(11)
    v_mfma_f32_32x32x16_bf16 a[144:159], a[8:11], v[72:75], a[144:159]
    buffer_load_dwordx4 v[136:139], v8, s[56:59], s83 offen offset:2048 sc1
    v_mfma_f32_32x32x16_bf16 a[160:175], a[12:15], v[72:75], a[160:175]
    v_mfma_f32_32x32x16_bf16 a[176:191], a[8:11], v[76:79], a[176:191]
    buffer_load_dwordx4 v[140:143], v9, s[56:59], s83 offen offset:2048 sc1
    v_mfma_f32_32x32x16_bf16 a[192:207], a[12:15], v[76:79], a[192:207]
    s_waitcnt vmcnt(11)
    v_mfma_f32_32x32x16_bf16 a[144:159], a[16:19], v[64:67], a[144:159]
    s_bfe_u32 s83, s6, 0x4001c
    s_lshl_b32 s83, s83, 12
    s_add_u32 s83, s83, s10
    buffer_load_dwordx4 v[144:147], v8, s[56:59], s83 offen offset:0 sc1
    v_mfma_f32_32x32x16_bf16 a[160:175], a[20:23], v[64:67], a[160:175]
    v_mfma_f32_32x32x16_bf16 a[176:191], a[16:19], v[68:71], a[176:191]
    buffer_load_dwordx4 v[148:151], v9, s[56:59], s83 offen offset:0 sc1
    v_mfma_f32_32x32x16_bf16 a[192:207], a[20:23], v[68:71], a[192:207]
    s_waitcnt vmcnt(11)
    v_mfma_f32_32x32x16_bf16 a[144:159], a[24:27], v[88:91], a[144:159]
HOP80:
    s_cbranch_execz HOP_RET
    buffer_load_dwordx4 v[152:155], v8, s[56:59], s83 offen offset:2048 sc1
    v_mfma_f32_32x32x16_bf16 a[160:175], a[28:31], v[88:91], a[160:175]
    v_mfma_f32_32x32x16_bf16 a[176:191], a[24:27], v[92:95], a[176:191]
    buffer_load_dwordx4 v[156:159], v9, s[56:59], s83 offen offset:2048 sc1
    v_mfma_f32_32x32x16_bf16 a[192:207], a[28:31], v[92:95], a[192:207]
    s_waitcnt vmcnt(11)
    s_waitcnt vmcnt(8)
POLL_23:
    v_cmp_ne_u32 vcc, s63, v1
    s_nop 0
    s_cbranch_vccz POLL_23_d
    s_cmp_eq_u32 s78, 0
    s_cbranch_scc1 POLL_23_d
    s_sub_u32 s78, s78, 1
    s_sleep 1
    buffer_load_dword v1, v20, s[56:59], s73 offen offset:64 sc1
    s_waitcnt vmcnt(0)
    s_branch POLL_23
POLL_23_d:
    v_mfma_f32_32x32x16_bf16 a[144:159], a[32:35], v[80:83], a[144:159]
    s_bfe_u32 s83, s8, 0x40000
    s_lshl_b32 s83, s83, 12
    s_add_u32 s83, s83, s10
    buffer_load_dwordx4 v[96:99], v8, s[56:59], s83 offen offset:0 sc1
    v_mfma_f32_32x32x16_bf16 a[160:175], a[36:39], v[80:83], a[160:175]
    v_mfma_f32_32x32x16_bf16 a[176:191], a[32:35], v[84:87], a[176:191]
    buffer_load_dwordx4 v[100:103], v9, s[56:59], s83 offen offset:0 sc1
    v_mfma_f32_32x32x16_bf16 a[192:207], a[36:39], v[84:87], a[192:207]
    v_mfma_f32_32x32x16_bf16 a[144:159], a[40:43], v[120:123], a[144:159]
    buffer_load_dwordx4 v[104:107], v8, s[56:59], s83 offen offset:2048 sc1
    v_mfma_f32_32x32x16_bf16 a[160:175], a[44:47], v[120:123], a[160:175]
    v_mfma_f32_32x32x16_bf16 a[176:191], a[40:43], v[124:127], a[176:191]
    buffer_load_dwordx4 v[108:111], v9, s[56:59], s83 offen offset:2048 sc1
    v_mfma_f32_32x32x16_bf16 a[192:207], a[44:47], v[124:127], a[192:207]
    s_waitcnt vmcnt(10)
    v_mfma_f32_32x32x16_bf16 a[144:159], a[48:51], v[128:131], a[144:159]
    s_bfe_u32 s83, s8, 0x40004
    s_lshl_b32 s83, s83, 12
    s_add_u32 s83, s83, s10
    buffer_load_dwordx4 v[112:115], v8, s[56:59], s83 offen offset:0 sc1
    v_mfma_f32_32x32x16_bf16 a[160:175], a[52:55], v[128:131], a[160:175]
HOP81:
    s_cbranch_execz HOP_RET
    v_mfma_f32_32x32x16_bf16 a[176:191], a[48:51], v[132:135], a[176:191]
    buffer_load_dwordx4 v[116:119], v9, s[56:59], s83 offen offset:0 sc1
    v_mfma_f32_32x32x16_bf16 a[192:207], a[52:55], v[132:135], a[192:207]
    s_waitcnt vmcnt(10)
    v_mfma_f32_32x32x16_bf16 a[144:159], a[56:59], v[136:139], a[144:159]
    buffer_load_dwordx4 v[40:43], v8, s[56:59], s83 offen offset:2048 sc1
    v_mfma_f32_32x32x16_bf16 a[160:175], a[60:63], v[136:139], a[160:175]
    v_mfma_f32_32x32x16_bf16 a[176:191], a[56:59], v[140:143], a[176:191]
    buffer_load_dwordx4 v[44:47], v9, s[56:59], s83 offen offset:2048 sc1
    v_mfma_f32_32x32x16_bf16 a[192:207], a[60:63], v[140:143], a[192:207]
    s_waitcnt vmcnt(10)
    s_waitcnt lgkmcnt(15)
    v_mfma_f32_32x32x16_bf16 a[144:159], a[64:67], v[144:147], a[144:159]
    s_bfe_u32 s83, s8, 0x40008
    s_lshl_b32 s83, s83, 12
    s_add_u32 s83, s83, s10
    buffer_load_dwordx4 v[32:35], v8, s[56:59], s83 offen offset:0 sc1
    v_mfma_f32_32x32x16_bf16 a[160:175], a[68:71], v[144:147], a[160:175]
    v_mfma_f32_32x32x16_bf16 a[176:191], a[64:67], v[148:151], a[176:191]
    buffer_load_dwordx4 v[36:39], v9, s[56:59], s83 offen offset:0 sc1
    v_mfma_f32_32x32x16_bf16 a[192:207], a[68:71], v[148:151], a[192:207]
    s_waitcnt vmcnt(10)
    v_mfma_f32_32x32x16_bf16 a[144:159], a[72:75], v[152:155], a[144:159]
    buffer_load_dwordx4 v[56:59], v8, s[56:59], s83 offen offset:2048 sc1
    v_mfma_f32_32x32x16_bf16 a[160:175], a[76:79], v[152:155], a[160:175]
    v_mfma_f32_32x32x16_bf16 a[176:191], a[72:75], v[156:159], a[176:191]
    buffer_load_dwordx4 v[60:63], v9, s[56:59], s83 offen offset:2048 sc1
    v_mfma_f32_32x32x16_bf16 a[192:207], a[76:79], v[156:159], a[192:207]
    s_waitcnt vmcnt(10)
    v_mfma_f32_32x32x16_bf16 a[144:159], v[224:227], v[96:99], a[144:159]
    s_bfe_u32 s83, s8, 0x4000c
    s_lshl_b32 s83, s83, 12
    s_add_u32 s83, s83, s10
    buffer_load_dwordx4 v[48:51], v8, s[56:59], s83 offen offset:0 sc1
    v_mfma_f32_32x32x16_bf16 a[160:175], v[228:231], v[96:99], a[160:175]
HOP82:
    s_cbranch_execz HOP_RET
    v_mfma_f32_32x32x16_bf16 a[176:191], v[224:227], v[100:103], a[176:191]
    buffer_load_dwordx4 v[52:55], v9, s[56:59], s83 offen offset:0 sc1
    v_mfma_f32_32x32x16_bf16 a[192:207], v[228:231], v[100:103], a[192:207]
    s_waitcnt vmcnt(10)
    v_mfma_f32_32x32x16_bf16 a[144:159], v[232:235], v[104:107], a[144:159]
    buffer_load_dwordx4 v[72:75], v8, s[56:59], s83 offen offset:2048 sc1
    v_mfma_f32_32x32x16_bf16 a[160:175], v[236:239], v[104:107], a[160:175]
    v_mfma_f32_32x32x16_bf16 a[176:191], v[232:235], v[108:111], a[176:191]
    buffer_load_dwordx4 v[76:79], v9, s[56:59], s83 offen offset:2048 sc1
    v_mfma_f32_32x32x16_bf16 a[192:207], v[236:239], v[108:111], a[192:207]
    s_waitcnt vmcnt(10)
    v_mfma_f32_32x32x16_bf16 a[144:159], v[240:243], v[112:115], a[144:159]
    s_bfe_u32 s83, s8, 0x40010
    s_lshl_b32 s83, s83, 12
    s_add_u32 s83, s83, s10
    buffer_load_dwordx4 v[64:67], v8, s[56:59], s83 offen offset:0 sc1
    v_mfma_f32_32x32x16_bf16 a[160:175], v[244:247], v[112:115], a[160:175]
    v_mfma_f32_32x32x16_bf16 a[176:191], v[240:243], v[116:119], a[176:191]
    buffer_load_dwordx4 v[68:71], v9, s[56:59], s83 offen offset:0 sc1
    v_mfma_f32_32x32x16_bf16 a[192:207], v[244:247], v[116:119], a[192:207]
    s_waitcnt vmcnt(10)
    v_mfma_f32_32x32x16_bf16 a[144:159], v[248:251], v[40:43], a[144:159]
    buffer_load_dwordx4 v[88:91], v8, s[56:59], s83 offen offset:2048 sc1
    v_mfma_f32_32x32x16_bf16 a[160:175], v[252:255], v[40:43], a[160:175]
    v_mfma_f32_32x32x16_bf16 a[176:191], v[248:251], v[44:47], a[176:191]
    buffer_load_dwordx4 v[92:95], v9, s[56:59], s83 offen offset:2048 sc1
    v_mfma_f32_32x32x16_bf16 a[192:207], v[252:255], v[44:47], a[192:207]
    s_waitcnt vmcnt(10)
    v_mfma_f32_32x32x16_bf16 a[144:159], a[80:83], v[32:35], a[144:159]
    s_bfe_u32 s83, s8, 0x40014
    s_lshl_b32 s83, s83, 12
    s_add_u32 s83, s83, s10
    buffer_load_dwordx4 v[80:83], v8, s[56:59], s83 offen offset:0 sc1
    v_mfma_f32_32x32x16_bf16 a[160:175], a[84:87], v[32:35], a[160:175]
    v_mfma_f32_32x32x16_bf16 a[176:191], a[80:83], v[36:39], a[176:191]
HOP83:
    s_cbranch_execz HOP_RET
    buffer_load_dwordx4 v[84:87], v9, s[56:59], s83 offen offset:0 sc1
    v_mfma_f32_32x32x16_bf16 a[192:207], a[84:87], v[36:39], a[192:207]
    s_waitcnt vmcnt(10)
    v_mfma_f32_32x32x16_bf16 a[144:159], a[88:91], v[56:59], a[144:159]
    buffer_load_dwordx4 v[120:123], v8, s[56:59], s83 offen offset:2048 sc1
    v_mfma_f32_32x32x16_bf16 a[160:175], a[92:95], v[56:59], a[160:175]
    v_mfma_f32_32x32x16_bf16 a[176:191], a[88:91], v[60:63], a[176:191]
    buffer_load_dwordx4 v[124:127], v9, s[56:59], s83 offen offset:2048 sc1
    v_mfma_f32_32x32x16_bf16 a[192:207], a[92:95], v[60:63], a[192:207]
    s_waitcnt vmcnt(10)
    v_mfma_f32_32x32x16_bf16 a[144:159], a[96:99], v[48:51], a[144:159]
    v_mfma_f32_32x32x16_bf16 a[160:175], a[100:103], v[48:51], a[160:175]
    v_mfma_f32_32x32x16_bf16 a[176:191], a[96:99], v[52:55], a[176:191]
    v_mfma_f32_32x32x16_bf16 a[192:207], a[100:103], v[52:55], a[192:207]
    s_waitcnt vmcnt(8)
    v_mfma_f32_32x32x16_bf16 a[144:159], a[104:107], v[72:75], a[144:159]
    v_mfma_f32_32x32x16_bf16 a[160:175], a[108:111], v[72:75], a[160:175]
    v_mfma_f32_32x32x16_bf16 a[176:191], a[104:107], v[76:79], a[176:191]
    v_mfma_f32_32x32x16_bf16 a[192:207], a[108:111], v[76:79], a[192:207]
    s_waitcnt vmcnt(6)
    s_waitcnt lgkmcnt(12)
    v_mfma_f32_32x32x16_bf16 a[144:159], a[112:115], v[64:67], a[144:159]
    v_mfma_f32_32x32x16_bf16 a[160:175], a[116:119], v[64:67], a[160:175]
    v_mfma_f32_32x32x16_bf16 a[176:191], a[112:115], v[68:71], a[176:191]
    v_mfma_f32_32x32x16_bf16 a[192:207], a[116:119], v[68:71], a[192:207]
    s_waitcnt vmcnt(4)
    s_waitcnt lgkmcnt(8)
    v_mfma_f32_32x32x16_bf16 a[144:159], a[120:123], v[88:91], a[144:159]
    v_mfma_f32_32x32x16_bf16 a[160:175], a[124:127], v[88:91], a[160:175]
    v_mfma_f32_32x32x16_bf16 a[176:191], a[120:123], v[92:95], a[176:191]
    v_mfma_f32_32x32x16_bf16 a[192:207], a[124:127], v[92:95], a[192:207]
    s_waitcnt vmcnt(2)
    s_waitcnt lgkmcnt(4)
    v_mfma_f32_32x32x16_bf16 a[144:159], a[128:131], v[80:83], a[144:159]
    v_mfma_f32_32x32x16_bf16 a[160:175], a[132:135], v[80:83], a[160:175]
HOP84:
    s_cbranch_execz HOP_RET
    v_mfma_f32_32x32x16_bf16 a[176:191], a[128:131], v[84:87], a[176:191]
    v_mfma_f32_32x32x16_bf16 a[192:207], a[132:135], v[84:87], a[192:207]
    s_waitcnt vmcnt(0)
    s_waitcnt lgkmcnt(0)
    v_mfma_f32_32x32x16_bf16 a[144:159], a[136:139], v[120:123], a[144:159]
    v_mfma_f32_32x32x16_bf16 a[160:175], a[140:143], v[120:123], a[160:175]
    v_mfma_f32_32x32x16_bf16 a[176:191], a[136:139], v[124:127], a[176:191]
    v_mfma_f32_32x32x16_bf16 a[192:207], a[140:143], v[124:127], a[192:207]
    s_add_u32 s65, s74, 65536
    v_add_u32 v4, s65, v10
    v_and_b32 v5, 31, v0
    s_lshr_b32 s65, s60, 1
    s_lshl_b32 s65, s65, 5
    s_lshl_b32 s66, s61, 6
    s_add_u32 s65, s65, s66
    v_add_u32 v5, s65, v5
    v_lshlrev_b32 v5, 10, v5
    v_lshrrev_b32 v6, 5, v0
    v_lshl_add_u32 v5, v6, 4, v5
    s_and_b32 s65, s60, 1
    s_lshl_b32 s65, s65, 6
    s_lshl_b32 s66, s62, 7
    s_add_u32 s65, s65, s66
    v_add_u32 v18, s65, v5
    ds_write_b128 v4, a[160:163] offset:4096
    ds_write_b128 v4, a[164:167] offset:5120
    ds_write_b128 v4, a[168:171] offset:6144
    ds_write_b128 v4, a[172:175] offset:7168
    ds_write_b128 v4, a[176:179] offset:8192
    ds_write_b128 v4, a[180:183] offset:9216
    ds_write_b128 v4, a[184:187] offset:10240
    ds_write_b128 v4, a[188:191] offset:11264
    ds_write_b128 v4, a[192:195] offset:12288
    ds_write_b128 v4, a[196:199] offset:13312
    ds_write_b128 v4, a[200:203] offset:14336
    ds_write_b128 v4, a[204:207] offset:15360
    v_accvgpr_read_b32 v32, a144
    v_accvgpr_read_b32 v33, a145
    v_accvgpr_read_b32 v34, a146
HOP85:
    s_cbranch_execz HOP_RET
    v_accvgpr_read_b32 v35, a147
    v_accvgpr_read_b32 v36, a148
    v_accvgpr_read_b32 v37, a149
    v_accvgpr_read_b32 v38, a150
    v_accvgpr_read_b32 v39, a151
    v_accvgpr_read_b32 v40, a152
    v_accvgpr_read_b32 v41, a153
    v_accvgpr_read_b32 v42, a154
    v_accvgpr_read_b32 v43, a155
    v_accvgpr_read_b32 v44, a156
    v_accvgpr_read_b32 v45, a157
    v_accvgpr_read_b32 v46, a158
    v_accvgpr_read_b32 v47, a159
    v_lshlrev_b32 v96, 16, v160
    v_and_b32 v97, 0xffff0000, v160
    v_lshlrev_b32 v98, 16, v161
    v_and_b32 v99, 0xffff0000, v161
    v_lshlrev_b32 v104, 16, v162
    v_and_b32 v105, 0xffff0000, v162
    v_lshlrev_b32 v106, 16, v163
    v_and_b32 v107, 0xffff0000, v163
    v_lshlrev_b32 v100, 16, v164
    v_and_b32 v101, 0xffff0000, v164
    v_lshlrev_b32 v102, 16, v165
    v_and_b32 v103, 0xffff0000, v165
    v_lshlrev_b32 v108, 16, v166
    v_and_b32 v109, 0xffff0000, v166
    v_lshlrev_b32 v110, 16, v167
    v_and_b32 v111, 0xffff0000, v167
    v_pk_add_f32 v[32:33], v[32:33], v[96:97]
    v_pk_add_f32 v[34:35], v[34:35], v[98:99]
    v_pk_add_f32 v[36:37], v[36:37], v[100:101]
    v_pk_add_f32 v[38:39], v[38:39], v[102:103]
    v_pk_add_f32 v[40:41], v[40:41], v[104:105]
    v_pk_add_f32 v[42:43], v[42:43], v[106:107]
HOP86:
    s_cbranch_execz HOP_RET
    v_pk_add_f32 v[44:45], v[44:45], v[108:109]
    v_pk_add_f32 v[46:47], v[46:47], v[110:111]
    s_waitcnt lgkmcnt(0)
    s_barrier
    s_xor_b32 s65, s60, 1
    s_lshl_b32 s65, s65, 14
    s_add_u32 s65, s65, 65536
    v_add_u32 v6, s65, v10
    ds_read_b128 v[48:51], v6 offset:4096
    ds_read_b128 v[52:55], v6 offset:5120
    ds_read_b128 v[56:59], v6 offset:6144
    ds_read_b128 v[60:63], v6 offset:7168
    s_xor_b32 s65, s60, 2
    s_lshl_b32 s65, s65, 14
    s_add_u32 s65, s65, 65536
    v_add_u32 v7, s65, v10
    ds_read_b128 v[64:67], v7 offset:8192
    ds_read_b128 v[68:71], v7 offset:9216
    ds_read_b128 v[72:75], v7 offset:10240
    ds_read_b128 v[76:79], v7 offset:11264
    s_xor_b32 s65, s60, 3
    s_lshl_b32 s65, s65, 14
    s_add_u32 s65, s65, 65536
    v_add_u32 v8, s65, v10
    ds_read_b128 v[80:83], v8 offset:12288
    ds_read_b128 v[84:87], v8 offset:13312
    ds_read_b128 v[88:91], v8 offset:14336
    ds_read_b128 v[92:95], v8 offset:15360
    s_or_b32 s65, s62, s60
    s_cmp_lg_u32 s65, 0
    s_cbranch_scc1 NOEPOCH
    s_mov_b64 exec, 1
    buffer_store_dword v21, off, s[56:59], s73 offset:2048 sc1
    s_mov_b64 exec, -1
NOEPOCH:
    s_waitcnt lgkmcnt(8)
    v_pk_add_f32 v[32:33], v[32:33], v[48:49]
    v_pk_add_f32 v[34:35], v[34:35], v[50:51]
    v_pk_add_f32 v[36:37], v[36:37], v[52:53]
    v_pk_add_f32 v[38:39], v[38:39], v[54:55]
HOP87:
    s_cbranch_execz HOP_RET
    v_pk_add_f32 v[40:41], v[40:41], v[56:57]
    v_pk_add_f32 v[42:43], v[42:43], v[58:59]
    v_pk_add_f32 v[44:45], v[44:45], v[60:61]
    v_pk_add_f32 v[46:47], v[46:47], v[62:63]
    s_waitcnt lgkmcnt(4)
    v_pk_add_f32 v[32:33], v[32:33], v[64:65]
    v_pk_add_f32 v[34:35], v[34:35], v[66:67]
    v_pk_add_f32 v[36:37], v[36:37], v[68:69]
    v_pk_add_f32 v[38:39], v[38:39], v[70:71]
    v_pk_add_f32 v[40:41], v[40:41], v[72:73]
    v_pk_add_f32 v[42:43], v[42:43], v[74:75]
    v_pk_add_f32 v[44:45], v[44:45], v[76:77]
    v_pk_add_f32 v[46:47], v[46:47], v[78:79]
    s_waitcnt lgkmcnt(0)
    v_pk_add_f32 v[32:33], v[32:33], v[80:81]
    v_pk_add_f32 v[34:35], v[34:35], v[82:83]
    v_pk_add_f32 v[36:37], v[36:37], v[84:85]
    v_pk_add_f32 v[38:39], v[38:39], v[86:87]
    v_pk_add_f32 v[40:41], v[40:41], v[88:89]
    v_pk_add_f32 v[42:43], v[42:43], v[90:91]
    v_pk_add_f32 v[44:45], v[44:45], v[92:93]
    v_pk_add_f32 v[46:47], v[46:47], v[94:95]
    v_cvt_pk_bf16_f32 v32, v32, v33
    v_cvt_pk_bf16_f32 v33, v34, v35
    v_cvt_pk_bf16_f32 v34, v36, v37
    v_cvt_pk_bf16_f32 v35, v38, v39
    v_cvt_pk_bf16_f32 v36, v40, v41
    v_cvt_pk_bf16_f32 v37, v42, v43
    v_cvt_pk_bf16_f32 v38, v44, v45
    v_cvt_pk_bf16_f32 v39, v46, v47
    s_nop 1
    v_permlane32_swap_b32 v32, v34
    v_permlane32_swap_b32 v33, v35
HOP88:
    s_cbranch_execz HOP_RET
    v_permlane32_swap_b32 v36, v38
    v_permlane32_swap_b32 v37, v39
    s_nop 1
    buffer_store_dwordx4 v[32:35], v18, s[52:55], 0 offen offset:0
    buffer_store_dwordx4 v[36:39], v18, s[52:55], 0 offen offset:32
    s_endpgm
XS_2:
    buffer_store_dwordx4 v[44:47], v10, s[56:59], s65 offen sc1
    buffer_store_dwordx4 v[48:51], v10, s[56:59], s66 offen sc1
    s_branch XS_2_r
XS_11:
    buffer_store_dwordx4 v[44:47], v10, s[56:59], s12 offen offset:0 sc1
    buffer_store_dwordx4 v[48:51], v10, s[56:59], s12 offen offset:1024 sc1
    s_branch XS_11_r
XS_20:
    buffer_store_dword v21, off, s[56:59], s69 offset:32 sc1
    s_branch XS_20_r
XS_22:
    buffer_store_dword v21, off, s[56:59], s69 offset:64 sc1
    s_branch XS_22_r
KEND:
    s_endpgm
HOP_TAB:
    s_branch HOP0
    s_branch HOP1
    s_branch HOP2
    s_branch HOP3
    s_branch HOP4
    s_branch HOP5
    s_branch HOP6
    s_branch HOP7
    s_branch HOP8
    s_branch HOP9
    s_branch HOP10
    s_branch HOP11
    s_branch HOP12
    s_branch HOP13
    s_branch HOP14
    s_branch HOP15
    s_branch HOP16
    s_branch HOP17
    s_branch HOP18
    s_branch HOP19
    s_branch HOP20
    s_branch HOP21
    s_branch HOP22
    s_branch HOP23
    s_branch HOP24
    s_branch HOP25
    s_branch HOP26
    s_branch HOP27
    s_branch HOP28
    s_branch HOP29
    s_branch HOP30
    s_branch HOP31
    s_branch HOP32
    s_branch HOP33
    s_branch HOP34
    s_branch HOP35
    s_branch HOP36
    s_branch HOP37
    s_branch HOP38
    s_branch HOP39
    s_branch HOP40
    s_branch HOP41
    s_branch HOP42
    s_branch HOP43
    s_branch HOP44
    s_branch HOP45
    s_branch HOP46
    s_branch HOP47
    s_branch HOP48
    s_branch HOP49
    s_branch HOP50
    s_branch HOP51
    s_branch HOP52
    s_branch HOP53
    s_branch HOP54
    s_branch HOP55
    s_branch HOP56
    s_branch HOP57
    s_branch HOP58
    s_branch HOP59
    s_branch HOP60
    s_branch HOP61
    s_branch HOP62
    s_branch HOP63
    s_branch HOP64
    s_branch HOP65
    s_branch HOP66
    s_branch HOP67
    s_branch HOP68
    s_branch HOP69
    s_branch HOP70
    s_branch HOP71
    s_branch HOP72
    s_branch HOP73
    s_branch HOP74
    s_branch HOP75
    s_branch HOP76
    s_branch HOP77
    s_branch HOP78
    s_branch HOP79
    s_branch HOP80
    s_branch HOP81
    s_branch HOP82
    s_branch HOP83
    s_branch HOP84
    s_branch HOP85
    s_branch HOP86
    s_branch HOP87
    s_branch HOP88
    s_branch HOP0
    s_branch HOP1
    s_branch HOP2
    s_branch HOP3
    s_branch HOP4
    s_branch HOP5
    s_branch HOP6
    s_branch HOP7
    s_branch HOP8
    s_branch HOP9
    s_branch HOP10
    s_branch HOP11
    s_branch HOP12
    s_branch HOP13
    s_branch HOP14
    s_branch HOP15
    s_branch HOP16
    s_branch HOP17
    s_branch HOP18
    s_branch HOP19
    s_branch HOP20
    s_branch HOP21
    s_branch HOP22
    s_branch HOP23
    s_branch HOP24
    s_branch HOP25
    s_branch HOP26
    s_branch HOP27
    s_branch HOP28
    s_branch HOP29
    s_branch HOP30
    s_branch HOP31
    s_branch HOP32
    s_branch HOP33
    s_branch HOP34
    s_branch HOP35
    s_branch HOP36
    s_branch HOP37
    s_branch HOP38
.section .rodata,"a"
.p2align 6
.amdhsa_kernel standalone__mixer_s_mlp__prompt_kernel
  .amdhsa_next_free_vgpr 512
  .amdhsa_next_free_sgpr 96
  .amdhsa_accum_offset 256
  .amdhsa_group_segment_fixed_size 0
  .amdhsa_kernarg_size 64
  .amdhsa_user_sgpr_count 2
  .amdhsa_user_sgpr_kernarg_segment_ptr 1
  .amdhsa_system_sgpr_workgroup_id_x 1
.end_amdhsa_kernel
```
